```python
import torch

def _softmax(x, axis=-1):
    return torch.softmax(x, dim=axis)
def _gelu(x):
    return torch.nn.functional.gelu(x, approximate="tanh")
def _silu(x):
    return torch.nn.functional.silu(x)
def _sigmoid(x):
    return torch.sigmoid(x)
def _layernorm(x, axis=-1, eps=1e-5):
    m = x.mean(dim=axis, keepdim=True)
    v = x.var(dim=axis, keepdim=True, unbiased=False)
    return (x - m) / torch.sqrt(v + eps)
def _scatter_add(tgt, idx, src, axis=0):
    return tgt.clone().index_add_(axis, idx, src)
def _segment_sum(src, seg, n):
    out = torch.zeros((n,) + src.shape[1:], dtype=src.dtype)
    return out.index_add_(0, seg, src)
def _pad(x, pw):
    flat = tuple(v for pair in reversed(pw) for v in pair)
    return torch.nn.functional.pad(x, flat)

kernel_name = 'parallel_sum__mha_block__dense_activation_relu__prompt'

def setup_inputs():

    _w = (lambda a: (lambda t: t.to(torch.bfloat16) if t.is_floating_point() else t)(torch.as_tensor(a)))
    def _A_setup():
        B, S, D, H = 1, 2048, 640, 32
        return {
            "x": _w((lambda *s: torch.randn(*s, dtype=torch.bfloat16) * 0.05)(B, S, D)),
            "wqkv": _w((lambda *s: torch.randn(*s, dtype=torch.bfloat16) * 0.2)(D, 3 * D)),
            "wo": _w((lambda *s: torch.randn(*s, dtype=torch.bfloat16) * 0.1)(D, D)),
        }
    _A_in = _A_setup()

    def _B_setup():
        B, S, D, Dff = 1, 2048, 640, 1728
        return {
            "x": _w((lambda *s: torch.randn(*s, dtype=torch.bfloat16) * 0.05)(B, S, D)),
            "w1": _w((lambda *s: torch.randn(*s, dtype=torch.bfloat16) * 0.2)(D, Dff)),
            "w2": _w((lambda *s: torch.randn(*s, dtype=torch.bfloat16) * 0.2)(Dff, D)),
        }
    _B_in = _B_setup()

    return {
        "A_x": _A_in["x"],
        "A_wqkv": _A_in["wqkv"],
        "A_wo": _A_in["wo"],
        "B_x": _B_in["x"],
        "B_w1": _B_in["w1"],
        "B_w2": _B_in["w2"],
    }

def reference(A_x, A_wqkv, A_wo, B_x, B_w1, B_w2):
    def _A_ref(x, wqkv, wo):
        B, S, D = x.shape
        H = 32
        Dh = D // H
        qkv = (lambda x, *d: x.permute(*d))((x @ wqkv).reshape(B, S, 3, H, Dh), 2, 0, 3, 1, 4)
        q, k, v = qkv[0], qkv[1], qkv[2]
        scores = torch.einsum("bhqd,bhkd->bhqk", q, k) * (Dh ** -0.5)
        p = _softmax(scores, axis=-1)
        o = torch.einsum("bhqk,bhkd->bhqd", p, v)
        return (lambda x, *d: x.permute(*d))(o, 0, 2, 1, 3).reshape(B, S, D) @ wo

    def _B_ref(x, w1, w2):
        h = torch.einsum("bsd,df->bsf", x, w1)
        zero = torch.zeros_like(h)
        h = torch.maximum(h, zero)
        return torch.einsum("bsf,fd->bsd", h, w2)

    x = A_x
    xn = _layernorm(x, axis=-1)
    return x + _A_ref(xn, A_wqkv, A_wo) + _B_ref(xn, B_w1, B_w2)
```

```asm
; @launch grid=(256,1,1) block=(512,1,1) lds=162368
.amdgcn_target "amdgcn-amd-amdhsa--gfx950"
.text
.globl parallel_sum__mha_block__dense_activation_relu__prompt_kernel
.p2align 8
.type parallel_sum__mha_block__dense_activation_relu__prompt_kernel,@function
parallel_sum__mha_block__dense_activation_relu__prompt_kernel:
    s_load_dwordx4 s[4:7], s[0:1], 0
    s_load_dwordx4 s[56:59], s[0:1], 32
    s_load_dwordx2 s[42:43], s[0:1], 64
    s_load_dwordx4 s[60:63], s[0:1], 48
    s_load_dwordx2 s[40:41], s[0:1], 16
    s_cmp_ge_u32 s2, 256
    s_cbranch_scc1 L_end
    s_getpc_b64 s[48:49]
L_pc:
    v_lshrrev_b32 v1, 6, v0
    v_and_b32 v255, 63, v0
    s_sub_u32 s48, s48, L_pc-parallel_sum__mha_block__dense_activation_relu__prompt_kernel
    s_subb_u32 s49, s49, 0
    v_readfirstlane_b32 s32, v1
    s_lshr_b32 s50, s2, 3
    s_mul_i32 s50, s50, 9
    v_min_u32 v2, 2, v255
    v_mad_u32_u24 v2, v1, 3, v2
    v_add_lshl_u32 v2, v2, s50, 7
    v_min_u32 v2, L_end-parallel_sum__mha_block__dense_activation_relu__prompt_kernel, v2
    global_load_dword v254, v2, s[48:49]
    s_and_b32 s36, s2, 7
    s_lshr_b32 s37, s2, 3
    s_cmp_lt_u32 s37, 3
    s_cbranch_scc1 L_stats
    s_mul_i32 s53, s36, 29
    s_add_u32 s53, s53, s37
    s_sub_u32 s53, s53, 3
    s_cmp_lt_u32 s32, 3
    s_cselect_b64 vcc, -1, 0
    s_cselect_b32 s50, 0, 3
    s_mov_b32 s18, 737280
    s_cselect_b32 s18, 2621440, s18
    s_cmp_lt_u32 s32, 6
    s_cselect_b32 s50, s50, 6
    s_cselect_b32 s52, 9, 12
    s_cselect_b32 s51, 3, 2
    s_cselect_b32 s18, s18, 663552
    s_mul_i32 s51, s51, s53
    s_sub_u32 s53, s32, s50
    s_add_u32 s51, s51, s53
    s_mul_i32 s53, s51, s52
    s_sub_u32 s52, s52, 1
    v_min_u32 v14, s52, v255
    v_add_lshl_u32 v14, v14, s53, 7
    v_min_u32 v2, 8, v255
    v_mul_u32_u24 v3, 342, v2
    v_lshrrev_b32 v3, 10, v3
    v_mul_u32_u24 v4, 896, v3
    v_lshl_add_u32 v2, v2, 7, v4
    s_mul_i32 s53, s51, 3840
    v_add_u32 v2, s53, v2
    v_cndmask_b32 v14, v14, v2, vcc
    s_mov_b32 s19, 0x20000
    s_cmp_eq_u32 s50, 3
    s_waitcnt lgkmcnt(0)
    s_cselect_b64 s[16:17], s[6:7], s[4:5]
    s_cmp_eq_u32 s50, 6
    s_cselect_b64 s[16:17], s[56:57], s[16:17]
    buffer_load_dword v253, v14, s[16:19], 0 offen
    s_cmp_lt_u32 s37, 18
    s_cselect_b32 s44, 3, 18
    s_cselect_b32 s48, 15, 14
    s_cselect_b32 s49, 0, 15
    s_movk_i32 s45, 3456
    s_cselect_b32 s45, 3840, s45
    s_and_b32 s50, s2, 3
    s_mul_i32 s48, s48, s50
    s_sub_u32 s44, s37, s44
    s_add_u32 s44, s44, s48
    s_lshr_b32 s34, s44, 2
    s_and_b32 s33, s44, 3
    s_and_b32 s48, s2, 4
    s_add_u32 s33, s33, s48
    s_lshl_b32 s47, s34, 8
    s_add_u32 s34, s34, s49
    v_lshrrev_b32 v2, 3, v255
    v_and_b32 v3, 7, v255
    v_lshrrev_b32 v4, 1, v2
    v_xor_b32 v4, v4, v3
    s_lshl_b32 s48, s33, 3
    s_add_u32 s48, s48, s32
    v_lshl_add_u32 v5, s48, 5, v2
    v_mul_u32_u24 v5, 1280, v5
    v_lshl_add_u32 v8, v4, 4, v5
    v_xor_b32 v4, 4, v4
    v_lshl_add_u32 v9, v4, 4, v5
    v_add_u32 v9, 9216, v9
    v_add_u32 v10, 18432, v8
    v_add_u32 v11, 18432, v9
    v_lshrrev_b32 v2, 4, v255
    v_and_b32 v3, 15, v255
    s_and_b32 s48, s32, 1
    s_lshl_b32 s48, s48, 3
    v_lshl_add_u32 v4, v2, 1, s48
    v_xor_b32 v6, v3, v4
    v_lshl_add_u32 v5, s32, 3, v2
    v_mul_u32_u24 v5, s45, v5
    v_lshl_add_u32 v12, v6, 4, v5
    s_lshl_b32 s48, s45, 2
    s_sub_u32 s48, s48, 1024
    v_add_u32 v13, s48, v12
    s_mov_b32 s10, 2621440
    s_mov_b32 s11, 0x20000
    s_mul_i32 s14, s45, 640
    s_mov_b32 s15, 0x20000
    s_lshl_b32 m0, s32, 12
    s_cmp_lt_u32 s37, 18
    s_waitcnt lgkmcnt(0)
    s_mov_b32 s8, s4
    s_mov_b32 s9, s5
    s_cselect_b32 s12, s6, s56
    s_cselect_b32 s13, s7, s57
    buffer_load_dwordx4 v8, s[8:11], 0 offen lds
    buffer_load_dwordx4 v9, s[8:11], 0 offen offset:1024 lds
    buffer_load_dwordx4 v10, s[8:11], 0 offen offset:2048 lds
    buffer_load_dwordx4 v11, s[8:11], 0 offen offset:3072 lds
    s_lshl_b32 s48, s32, 11
    s_add_u32 m0, s48, 32768
    s_mul_i32 s35, s34, 52
    buffer_load_dwordx4 v12, s[12:15], s47 offen lds
    buffer_load_dwordx4 v13, s[12:15], s47 offen offset:1024 lds
    s_lshr_b32 s35, s35, 8
    s_min_u32 s35, s35, 3
    s_cmp_lt_u32 s32, 4
    s_cbranch_scc1 L_compute
    s_setprio 1
    s_sub_u32 s44, s32, 4
    s_sub_u32 s38, s44, 4
    s_mul_i32 s38, s38, 40960
    v_add_u32 v11, s38, v11
    v_add_u32 v10, s38, v10
    v_add_u32 v9, s38, v9
    v_add_u32 v8, s38, v8
    v_lshlrev_b32 v4, 1, v2
    v_xor_b32 v4, v3, v4
    v_lshl_add_u32 v5, s44, 4, v2
    v_mul_u32_u24 v5, s45, v5
    v_lshl_add_u32 v16, v4, 4, v5
    v_xor_b32 v4, 8, v4
    v_lshl_add_u32 v18, v4, 4, v5
    s_lshl_b32 s38, s45, 2
    s_sub_u32 s38, s38, 1024
    s_lshl_b32 s39, s38, 1
    v_add_u32 v17, s38, v16
    v_add_u32 v18, s39, v18
    v_add_u32 v19, s38, v18
    s_lshl_b32 s48, s45, 6
    s_movk_i32 s46, 128
    s_add_u32 s47, s47, s48
    s_lshl_b32 s49, s44, 13
    s_lshl_b32 s50, s44, 12
    s_add_u32 s50, s50, 32768
    v_add_u32 v12, 40960, v8
    v_add_u32 v13, 40960, v9
    v_add_u32 v14, 40960, v10
    v_add_u32 v15, 40960, v11
    s_add_u32 m0, s49, 49152
    s_nop 0
    buffer_load_dwordx4 v8, s[8:11], s46 offen offset:0 lds
    buffer_load_dwordx4 v9, s[8:11], s46 offen offset:1024 lds
    buffer_load_dwordx4 v10, s[8:11], s46 offen offset:2048 lds
    buffer_load_dwordx4 v11, s[8:11], s46 offen offset:3072 lds
    s_mov_b32 s51, 0
    s_mov_b32 s52, 0
    s_mov_b32 s54, 98304
    s_cmp_eq_u32 s35, 2
    s_cselect_b32 s3, 2, 3
    v_lshlrev_b32 v97, s3, v255
    v_add_u32 v97, 159744, v97
    s_cselect_b32 s3, 1024, 4
    v_add_u32 v96, s3, v97
    v_lshlrev_b32 v98, 2, v255
    v_lshlrev_b32 v95, 3, v255
    v_add_u32 v92, 161792, v98
    v_and_b32 v94, 3, v255
    v_lshlrev_b32 v94, 6, v94
    s_add_u32 s20, s42, 17612800
    s_addc_u32 s21, s43, 0
    s_mov_b32 s22, 185856
    s_mov_b32 s23, 0x20000
    s_mov_b32 s24, s62
    s_mov_b32 s25, s63
    s_mov_b32 s26, 256
    s_mov_b32 s27, 0x20000
    s_waitcnt vmcnt(4)
    s_barrier
    s_setprio 0
    s_add_u32 m0, s50, 49152
    s_nop 0
    buffer_load_dwordx4 v16, s[12:15], s47 offen offset:0 lds
    buffer_load_dwordx4 v17, s[12:15], s47 offen offset:1024 lds
    buffer_load_dwordx4 v18, s[12:15], s47 offen offset:2048 lds
    buffer_load_dwordx4 v19, s[12:15], s47 offen offset:3072 lds
    s_add_u32 m0, s49, 53248
    s_nop 0
    buffer_load_dwordx4 v12, s[8:11], s46 offen offset:0 lds
    buffer_load_dwordx4 v13, s[8:11], s46 offen offset:1024 lds
    buffer_load_dwordx4 v14, s[8:11], s46 offen offset:2048 lds
    buffer_load_dwordx4 v15, s[8:11], s46 offen offset:3072 lds
    s_add_u32 s46, s46, 128
    s_add_u32 s47, s47, s48
L_hloop:
    s_add_u32 s3, s49, s54
    s_add_u32 s55, s50, s54
    s_add_u32 m0, s3, 0
    s_nop 0
    buffer_load_dwordx4 v8, s[8:11], s46 offen offset:0 lds
    buffer_load_dwordx4 v9, s[8:11], s46 offen offset:1024 lds
    buffer_load_dwordx4 v10, s[8:11], s46 offen offset:2048 lds
    buffer_load_dwordx4 v11, s[8:11], s46 offen offset:3072 lds
    s_add_u32 m0, s55, 0
    s_nop 0
    buffer_load_dwordx4 v16, s[12:15], s47 offen offset:0 lds
    buffer_load_dwordx4 v17, s[12:15], s47 offen offset:1024 lds
    buffer_load_dwordx4 v18, s[12:15], s47 offen offset:2048 lds
    buffer_load_dwordx4 v19, s[12:15], s47 offen offset:3072 lds
    s_add_u32 m0, s3, 4096
    s_nop 0
    buffer_load_dwordx4 v12, s[8:11], s46 offen offset:0 lds
    buffer_load_dwordx4 v13, s[8:11], s46 offen offset:1024 lds
    buffer_load_dwordx4 v14, s[8:11], s46 offen offset:2048 lds
    buffer_load_dwordx4 v15, s[8:11], s46 offen offset:3072 lds
    s_add_u32 s46, s46, 128
    s_add_u32 s47, s47, s48
    s_mov_b32 s54, s52
    s_add_u32 s52, s52, 49152
    s_cmp_eq_u32 s52, 147456
    s_cselect_b32 s52, 0, s52
    s_add_u32 s51, s51, 1
    s_cmp_eq_u32 s51, 8
    s_waitcnt vmcnt(12)
    s_cbranch_scc1 L_h8
    s_barrier
    s_branch L_hloop
L_h8:
    s_barrier
    s_cmp_eq_u32 s44, 0
    s_cbranch_scc1 L_h_first
    s_add_u32 s8, s42, 14974976
    s_addc_u32 s9, s43, 0
    s_mov_b32 s10, 2637824
    s_mov_b32 s11, 0x20000
    s_cmp_lg_u32 s35, 3
    s_cselect_b32 s10, 0, s10
    s_mul_i32 s38, s33, 14
    s_add_u32 s38, s38, s34
    s_sub_u32 s38, s38, 15
    s_mul_i32 s38, s38, 23
    s_lshl_b32 s3, s44, 3
    s_sub_u32 s3, s3, 8
    s_min_u32 s3, s3, 15
    s_add_u32 s38, s38, s3
    s_lshl_b32 s38, s38, 10
    v_lshlrev_b32 v2, 4, v255
    v_add_u32 v3, 4096, v2
    v_mov_b32 v4, -1
    v_mov_b32 v5, -1
    v_mov_b32 v6, -1
    v_mov_b32 v7, -1
    buffer_store_dwordx4 v[4:7], v2, s[8:11], s38 offen offset:0 sc1
    buffer_store_dwordx4 v[4:7], v2, s[8:11], s38 offen offset:1024 sc1
    buffer_store_dwordx4 v[4:7], v2, s[8:11], s38 offen offset:2048 sc1
    buffer_store_dwordx4 v[4:7], v2, s[8:11], s38 offen offset:3072 sc1
    buffer_store_dwordx4 v[4:7], v3, s[8:11], s38 offen offset:0 sc1
    buffer_store_dwordx4 v[4:7], v3, s[8:11], s38 offen offset:1024 sc1
    buffer_store_dwordx4 v[4:7], v3, s[8:11], s38 offen offset:2048 sc1
    buffer_store_dwordx4 v[4:7], v3, s[8:11], s38 offen offset:3072 sc1
    s_mov_b32 s12, s58
    s_mov_b32 s13, s59
    s_mov_b32 s14, 2211840
    s_mov_b32 s15, 0x20000
    s_mov_b32 s16, s40
    s_mov_b32 s17, s41
    s_mov_b32 s18, 819200
    s_mov_b32 s19, 0x20000
    s_mul_i32 s38, s36, 29
    s_add_u32 s38, s38, s37
    s_mul_i32 s38, s38, 3
    s_add_u32 s38, s38, s44
    s_sub_u32 s38, s38, 10
    s_mul_i32 s3, s38, 3200
    s_mul_i32 s38, s38, 1280
    v_min_u32 v8, 24, v255
    v_min_u32 v9, 9, v255
    v_lshlrev_b32 v8, 7, v8
    v_lshlrev_b32 v9, 7, v9
    buffer_load_dword v250, v8, s[12:15], s3 offen
    buffer_load_dword v250, v9, s[16:19], s38 offen
    s_waitcnt vmcnt(10)
    s_barrier
    s_barrier
    s_barrier
L_b_phase2b:
    s_lshl_b32 s38, s34, 3
    s_add_u32 s38, s38, s33
    s_lshl_b32 s38, s38, 7
    s_add_u32 s38, s38, 120320
    v_mov_b32 v207, s38
    v_lshlrev_b32 v229, 4, v255
    v_add_u32 v200, 16, v255
    v_mul_u32_u24 v201, 2731, v200
    v_lshrrev_b32 v201, 16, v201
    v_mul_u32_u24 v202, 24, v201
    v_sub_u32 v200, v200, v202
    v_lshrrev_b32 v202, 2, v200
    v_and_b32 v200, 3, v200
    v_lshlrev_b32 v200, 4, v200
    v_lshl_add_u32 v200, v201, 6, v200
    v_lshl_add_u32 v200, v202, 8, v200
    v_add_u32 v230, 1152, v200
    v_add_u32 v200, 80, v255
    v_mul_u32_u24 v201, 2731, v200
    v_lshrrev_b32 v201, 16, v201
    v_mul_u32_u24 v202, 24, v201
    v_sub_u32 v200, v200, v202
    v_lshrrev_b32 v202, 2, v200
    v_and_b32 v200, 3, v200
    v_lshlrev_b32 v200, 4, v200
    v_lshl_add_u32 v200, v201, 6, v200
    v_lshl_add_u32 v200, v202, 8, v200
    v_add_u32 v231, 1152, v200
    v_cmp_gt_u32 vcc, 32, v255
    v_add_u32 v203, 1024, v229
    s_nop 0
    v_cndmask_b32 v230, v230, v203, vcc
    s_lshr_b32 s38, s37, 3
    s_lshl_b32 s39, s36, 2
    s_add_u32 s38, s38, s39
    s_mul_i32 s3, s38, 20
    s_mul_i32 s38, s38, 164096
    s_mul_i32 s52, s44, 2560
    s_add_u32 s52, s52, s38
    s_mul_i32 s54, s44, 3072
    s_add_u32 s30, s54, 49152
    s_and_b32 s45, s37, 7
    s_lshl_b32 s45, s45, 2
    s_lshr_b32 s38, s36, 1
    s_add_u32 s45, s45, s38
    s_and_b32 s46, s36, 1
    s_lshl_b32 s46, s46, 2
    s_lshr_b32 s38, s37, 3
    s_add_u32 s46, s46, s38
    s_mul_i32 s39, s44, 14
    s_cmp_eq_u32 s44, 3
    s_cselect_b32 s39, 41, s39
    s_mul_i32 s47, s39, 40960
    s_mul_i32 s38, s46, 160
    s_add_u32 s47, s47, s38
    s_mul_i32 s48, s45, 221696
    s_lshl_b32 s38, s39, 11
    s_add_u32 s48, s48, s38
    s_mul_i32 s49, s44, 27648
    s_add_u32 s49, s49, 49152
    s_add_u32 s50, s49, 18432
    s_mov_b32 s51, 18432
    s_add_u32 s31, s49, 27648
    v_lshlrev_b32 v232, 4, v255
    v_add_u32 v233, 110848, v232
    s_add_u32 s8, s42, 2629632
    s_addc_u32 s9, s43, 0
    s_mov_b32 s10, 5251072
    s_mov_b32 s11, 0x20000
    s_mov_b32 s12, s58
    s_mov_b32 s13, s59
    s_mov_b32 s14, 2211840
    s_mov_b32 s15, 0x20000
    s_add_u32 s16, s42, 7880704
    s_addc_u32 s17, s43, 0
    s_mov_b32 s18, 7094272
    s_mov_b32 s19, 0x20000
    v_add_u32 v200, 0, v255
    v_mul_u32_u24 v201, 6554, v200
    v_lshrrev_b32 v201, 16, v201
    v_mul_u32_u24 v202, 10, v201
    v_sub_u32 v200, v200, v202
    v_mul_u32_u24 v201, 1280, v201
    v_lshl_add_u32 v224, v200, 4, v201
    v_add_u32 v200, 64, v255
    v_mul_u32_u24 v201, 6554, v200
    v_lshrrev_b32 v201, 16, v201
    v_mul_u32_u24 v202, 10, v201
    v_sub_u32 v200, v200, v202
    v_mul_u32_u24 v201, 1280, v201
    v_lshl_add_u32 v225, v200, 4, v201
    v_subrev_u32 v225, 1024, v225
    v_add_u32 v200, 128, v255
    v_mul_u32_u24 v201, 6554, v200
    v_lshrrev_b32 v201, 16, v201
    v_mul_u32_u24 v202, 10, v201
    v_sub_u32 v200, v200, v202
    v_mul_u32_u24 v201, 1280, v201
    v_lshl_add_u32 v226, v200, 4, v201
    v_subrev_u32 v226, 2048, v226
    v_add_u32 v200, 192, v255
    v_mul_u32_u24 v201, 6554, v200
    v_lshrrev_b32 v201, 16, v201
    v_mul_u32_u24 v202, 10, v201
    v_sub_u32 v200, v200, v202
    v_mul_u32_u24 v201, 1280, v201
    v_lshl_add_u32 v227, v200, 4, v201
    v_subrev_u32 v227, 3072, v227
    v_add_u32 v200, 256, v255
    v_mul_u32_u24 v201, 6554, v200
    v_lshrrev_b32 v201, 16, v201
    v_mul_u32_u24 v202, 10, v201
    v_sub_u32 v200, v200, v202
    v_mul_u32_u24 v201, 1280, v201
    v_lshl_add_u32 v228, v200, 4, v201
    v_and_b32 v200, 15, v255
    v_lshrrev_b32 v201, 4, v255
    v_lshrrev_b32 v202, 2, v255
    v_mul_u32_u24 v202, 160, v202
    v_and_b32 v203, 3, v255
    v_lshl_add_u32 v202, v203, 3, v202
    v_add_u32 v234, s49, v202
    v_lshlrev_b32 v202, 8, v201
    v_lshl_add_u32 v202, v200, 3, v202
    v_add_u32 v202, 5120, v202
    v_add_u32 v235, s49, v202
    v_bfe_u32 v204, v255, 3, 1
    v_mul_u32_u24 v204, 19, v204
    v_add_u32 v204, s3, v204
    v_lshrrev_b32 v204, 7, v204
    v_mul_u32_u24 v205, 5, v201
    v_add_u32 v204, v204, v205
    v_and_b32 v205, 7, v255
    v_lshl_add_u32 v204, v204, 3, v205
    v_lshlrev_b32 v204, 7, v204
    v_add_u32 v204, 120320, v204
    s_lshr_b32 s38, s45, 2
    s_lshl_b32 s38, s38, 7
    s_add_u32 s38, s38, 135680
    v_lshl_add_u32 v205, v255, 10, s38
    v_and_b32 v208, 15, v255
    v_lshrrev_b32 v209, 4, v255
    v_lshrrev_b32 v210, 1, v209
    v_and_b32 v211, 1, v209
    v_mul_u32_u24 v212, 1280, v210
    v_lshl_add_u32 v212, v211, 9, v212
    v_lshl_add_u32 v241, v208, 4, v212
    v_mul_u32_u24 v212, 2560, v209
    v_lshl_add_u32 v242, v208, 3, v212
    v_mul_u32_u24 v210, 20, v210
    v_lshl_add_u32 v210, v211, 2, v210
    v_lshrrev_b32 v212, 2, v208
    v_add_u32 v210, v210, v212
    v_mul_u32_u24 v210, 160, v210
    v_and_b32 v213, 3, v208
    v_lshl_add_u32 v213, v213, 3, s49
    v_add_u32 v213, 2048, v213
    v_add_u32 v239, v210, v213
    v_mul_u32_u24 v210, 40, v209
    v_add3_u32 v210, v210, v212, 16
    v_mul_u32_u24 v210, 160, v210
    v_add_u32 v240, v210, v213
    v_mul_u32_u24 v208, 336, v208
    v_lshl_add_u32 v208, v209, 4, v208
    v_add_u32 v243, s49, v208
    s_mul_i32 s3, s45, 82432
    s_mul_i32 s38, s44, 10240
    s_add_u32 s3, s3, s38
    v_and_b32 v208, 7, v255
    v_mul_u32_u24 v208, 1280, v208
    v_bfe_u32 v209, v255, 3, 1
    v_mul_u32_u24 v209, 41216, v209
    v_add3_u32 v208, v208, v209, s3
    v_add_u32 v244, 1272, v208
    v_add_u32 v208, 192, v255
    v_mul_u32_u24 v209, 3277, v208
    v_lshrrev_b32 v209, 16, v209
    v_mul_u32_u24 v210, 20, v209
    v_sub_u32 v208, v208, v210
    v_lshl_add_u32 v209, s44, 4, v209
    v_mul_u32_u24 v210, 336, v209
    v_lshl_add_u32 v210, v208, 4, v210
    v_add_u32 v247, 49152, v210
    v_and_b32 v210, 1, v209
    v_lshlrev_b32 v210, 4, v210
    v_bfe_u32 v211, v209, 1, 4
    v_and_b32 v209, 32, v209
    v_add3_u32 v209, v209, v210, v211
    v_mul_u32_u24 v209, 1280, v209
    v_lshl_add_u32 v245, v208, 3, v209
    v_add_u32 v208, 256, v255
    v_mul_u32_u24 v209, 3277, v208
    v_lshrrev_b32 v209, 16, v209
    v_mul_u32_u24 v210, 20, v209
    v_sub_u32 v208, v208, v210
    v_lshl_add_u32 v209, s44, 4, v209
    v_mul_u32_u24 v210, 336, v209
    v_lshl_add_u32 v210, v208, 4, v210
    v_add_u32 v251, 49152, v210
    v_and_b32 v210, 1, v209
    v_lshlrev_b32 v210, 4, v210
    v_bfe_u32 v211, v209, 1, 4
    v_and_b32 v209, 32, v209
    v_add3_u32 v209, v209, v210, v211
    v_mul_u32_u24 v209, 1280, v209
    v_lshl_add_u32 v246, v208, 3, v209
    v_mov_b32 v0, 0
    v_mov_b32 v1, 0
    v_mov_b32 v2, 0
    v_mov_b32 v3, 0
    v_mov_b32 v4, 0
    v_mov_b32 v5, 0
    v_mov_b32 v6, 0
    v_mov_b32 v7, 0
    v_mov_b32 v8, 0
    v_mov_b32 v9, 0
    v_mov_b32 v10, 0
    v_mov_b32 v11, 0
    v_mov_b32 v12, 0
    v_mov_b32 v13, 0
    v_mov_b32 v14, 0
    v_mov_b32 v15, 0
    v_mov_b32 v16, 0
    v_mov_b32 v17, 0
    v_mov_b32 v18, 0
    v_mov_b32 v19, 0
    v_mov_b32 v20, 0
    v_mov_b32 v21, 0
    v_mov_b32 v22, 0
    v_mov_b32 v23, 0
    v_mov_b32 v24, 0
    v_mov_b32 v25, 0
    v_mov_b32 v26, 0
    v_mov_b32 v27, 0
    v_mov_b32 v28, 0
    v_mov_b32 v29, 0
    v_mov_b32 v30, 0
    v_mov_b32 v31, 0
    v_mov_b32 v32, 0
    v_mov_b32 v33, 0
    v_mov_b32 v34, 0
    v_mov_b32 v35, 0
    v_mov_b32 v36, 0
    v_mov_b32 v37, 0
    v_mov_b32 v38, 0
    v_mov_b32 v39, 0
    v_mov_b32 v40, 0
    v_mov_b32 v41, 0
    v_mov_b32 v42, 0
    v_mov_b32 v43, 0
    v_mov_b32 v44, 0
    v_mov_b32 v45, 0
    v_mov_b32 v46, 0
    v_mov_b32 v47, 0
    v_mov_b32 v48, 0
    v_mov_b32 v49, 0
    v_mov_b32 v50, 0
    v_mov_b32 v51, 0
    v_mov_b32 v52, 0
    v_mov_b32 v53, 0
    v_mov_b32 v54, 0
    v_mov_b32 v55, 0
    v_mov_b32 v56, 0
    v_mov_b32 v57, 0
    v_mov_b32 v58, 0
    v_mov_b32 v59, 0
    v_mov_b32 v60, 0
    v_mov_b32 v61, 0
    v_mov_b32 v62, 0
    v_mov_b32 v63, 0
    v_mov_b32 v64, 0
    v_mov_b32 v65, 0
    v_mov_b32 v66, 0
    v_mov_b32 v67, 0
    v_mov_b32 v68, 0
    v_mov_b32 v69, 0
    v_mov_b32 v70, 0
    v_mov_b32 v71, 0
    v_mov_b32 v72, 0
    v_mov_b32 v73, 0
    v_mov_b32 v74, 0
    v_mov_b32 v75, 0
    v_mov_b32 v76, 0
    v_mov_b32 v77, 0
    v_mov_b32 v78, 0
    v_mov_b32 v79, 0
    s_setprio 1
    s_cmp_lg_u32 s44, 1
    s_cbranch_scc1 L_b_p2
    v_mov_b32 v248, 162308
    s_mov_b32 s53, 0
L_lw_kv_1:
    ds_read_b32 v249, v248
    s_add_u32 s53, s53, 1
    s_waitcnt lgkmcnt(0)
    v_cmp_gt_u32 vcc, 4, v249
    s_cmp_gt_u32 s53, 131072
    s_cbranch_scc1 L_lwd_kv_2
    s_cbranch_vccz L_lwd_kv_2
    s_sleep 2
    s_branch L_lw_kv_1
L_lwd_kv_2:
    s_mov_b32 exec_lo, 4294967295
    s_mov_b32 exec_hi, 65535
    s_mov_b32 s53, 0
L_poll_kv_3:
    buffer_load_dword v206, v204, s[20:23], 0 offen sc1
    s_add_u32 s53, s53, 1
    s_waitcnt vmcnt(0)
    v_cmp_gt_u32 vcc, 1, v206
    s_cmp_gt_u32 s53, 32768
    s_cbranch_scc1 L_polled_kv_4
    s_cbranch_vccz L_polled_kv_4
    s_sleep 1
    s_branch L_poll_kv_3
L_polled_kv_4:
    s_mov_b64 exec, -1
L_b_p2:
    s_barrier
    s_mov_b32 m0, s54
    s_add_u32 s54, s54, 12288
    buffer_load_dwordx4 v229, s[8:11], s52 offen lds
    s_add_u32 m0, m0, 1024
    s_mov_b32 exec_lo, 65535
    s_mov_b32 exec_hi, 4279238655
    buffer_load_dwordx4 v230, s[8:11], s52 offen lds
    s_add_u32 m0, m0, 1024
    s_mov_b32 exec_lo, 4294905855
    s_mov_b32 exec_hi, 268435215
    buffer_load_dwordx4 v231, s[8:11], s52 offen lds
    s_mov_b64 exec, -1
    s_add_u32 s52, s52, 10240
    s_cmp_eq_u32 s54, s30
    s_cselect_b32 s38, 49152, 0
    s_sub_u32 s54, s54, s38
    s_mov_b32 m0, s54
    s_add_u32 s54, s54, 12288
    buffer_load_dwordx4 v229, s[8:11], s52 offen lds
    s_add_u32 m0, m0, 1024
    s_mov_b32 exec_lo, 65535
    s_mov_b32 exec_hi, 4279238655
    buffer_load_dwordx4 v230, s[8:11], s52 offen lds
    s_add_u32 m0, m0, 1024
    s_mov_b32 exec_lo, 4294905855
    s_mov_b32 exec_hi, 268435215
    buffer_load_dwordx4 v231, s[8:11], s52 offen lds
    s_mov_b64 exec, -1
    s_add_u32 s52, s52, 10240
    s_cmp_eq_u32 s54, s30
    s_cselect_b32 s38, 49152, 0
    s_sub_u32 s54, s54, s38
    s_mov_b32 m0, s54
    s_add_u32 s54, s54, 12288
    buffer_load_dwordx4 v229, s[8:11], s52 offen lds
    s_add_u32 m0, m0, 1024
    s_mov_b32 exec_lo, 65535
    s_mov_b32 exec_hi, 4279238655
    buffer_load_dwordx4 v230, s[8:11], s52 offen lds
    s_add_u32 m0, m0, 1024
    s_mov_b32 exec_lo, 4294905855
    s_mov_b32 exec_hi, 268435215
    buffer_load_dwordx4 v231, s[8:11], s52 offen lds
    s_mov_b64 exec, -1
    s_add_u32 s52, s52, 10240
    s_cmp_eq_u32 s54, s30
    s_cselect_b32 s38, 49152, 0
    s_sub_u32 s54, s54, s38
    s_lshl_b32 s38, s44, 14
    s_add_u32 s38, s38, 49152
    v_lshl_add_u32 v200, v255, 4, s38
    ds_read_b128 v[80:83], v200 offset:0
    ds_read_b128 v[84:87], v200 offset:1024
    ds_read_b128 v[88:91], v200 offset:2048
    ds_read_b128 v[92:95], v200 offset:3072
    ds_read_b128 v[96:99], v200 offset:4096
    ds_read_b128 v[100:103], v200 offset:5120
    ds_read_b128 v[104:107], v200 offset:6144
    ds_read_b128 v[108:111], v200 offset:7168
    ds_read_b128 v[112:115], v200 offset:8192
    ds_read_b128 v[116:119], v200 offset:9216
    ds_read_b128 v[120:123], v200 offset:10240
    ds_read_b128 v[124:127], v200 offset:11264
    ds_read_b128 v[128:131], v200 offset:12288
    ds_read_b128 v[132:135], v200 offset:13312
    ds_read_b128 v[136:139], v200 offset:14336
    ds_read_b128 v[140:143], v200 offset:15360
    s_add_u32 s24, s42, 7880704
    s_addc_u32 s25, s43, 0
    s_mov_b32 s26, 7094272
    s_mov_b32 s27, 0x20000
    s_and_b32 s38, s44, 1
    s_lshl_b32 s38, s38, 2
    s_lshl_b32 s28, s33, 3
    s_add_u32 s28, s28, s38
    s_mul_i32 s28, s28, 110848
    s_sub_u32 s38, s34, 15
    s_lshl_b32 s38, s38, 1
    s_lshr_b32 s3, s44, 1
    s_add_u32 s38, s38, s3
    s_cmp_ge_u32 s38, 27
    s_cselect_b32 s26, 0, s26
    s_lshl_b32 s38, s38, 12
    s_add_u32 s28, s28, s38
    s_waitcnt lgkmcnt(0)
    s_waitcnt vmcnt(6)
    s_setprio 0
    s_barrier
    buffer_store_dwordx4 v[80:83], v232, s[24:27], s28 offen offset:0 sc1
    buffer_store_dwordx4 v[84:87], v232, s[24:27], s28 offen offset:1024 sc1
    buffer_store_dwordx4 v[88:91], v232, s[24:27], s28 offen offset:2048 sc1
    buffer_store_dwordx4 v[92:95], v232, s[24:27], s28 offen offset:3072 sc1
    s_add_u32 s28, s28, 110848
    buffer_store_dwordx4 v[96:99], v232, s[24:27], s28 offen offset:0 sc1
    buffer_store_dwordx4 v[100:103], v232, s[24:27], s28 offen offset:1024 sc1
    buffer_store_dwordx4 v[104:107], v232, s[24:27], s28 offen offset:2048 sc1
    buffer_store_dwordx4 v[108:111], v232, s[24:27], s28 offen offset:3072 sc1
    s_add_u32 s28, s28, 110848
    buffer_store_dwordx4 v[112:115], v232, s[24:27], s28 offen offset:0 sc1
    buffer_store_dwordx4 v[116:119], v232, s[24:27], s28 offen offset:1024 sc1
    s_waitcnt vmcnt(13)
    s_barrier
    s_mov_b32 m0, s54
    s_add_u32 s54, s54, 12288
    buffer_load_dwordx4 v229, s[8:11], s52 offen lds
    s_add_u32 m0, m0, 1024
    s_mov_b32 exec_lo, 65535
    s_mov_b32 exec_hi, 4279238655
    buffer_load_dwordx4 v230, s[8:11], s52 offen lds
    s_add_u32 m0, m0, 1024
    s_mov_b32 exec_lo, 4294905855
    s_mov_b32 exec_hi, 268435215
    buffer_load_dwordx4 v231, s[8:11], s52 offen lds
    s_mov_b64 exec, -1
    s_add_u32 s52, s52, 10240
    s_cmp_eq_u32 s54, s30
    s_cselect_b32 s38, 49152, 0
    s_sub_u32 s54, s54, s38
    buffer_store_dwordx4 v[120:123], v232, s[24:27], s28 offen offset:2048 sc1
    buffer_store_dwordx4 v[124:127], v232, s[24:27], s28 offen offset:3072 sc1
    s_add_u32 s28, s28, 110848
    buffer_store_dwordx4 v[128:131], v232, s[24:27], s28 offen offset:0 sc1
    buffer_store_dwordx4 v[132:135], v232, s[24:27], s28 offen offset:1024 sc1
    buffer_store_dwordx4 v[136:139], v232, s[24:27], s28 offen offset:2048 sc1
    buffer_store_dwordx4 v[140:143], v232, s[24:27], s28 offen offset:3072 sc1
    s_add_u32 s28, s28, 110848
    s_add_u32 s3, s49, 18432
    s_add_u32 m0, s3, 0
    s_nop 0
    buffer_load_dwordx4 v224, s[12:15], s47 offen offset:0 lds
    buffer_load_dwordx4 v225, s[12:15], s47 offen offset:1024 lds
    buffer_load_dwordx4 v226, s[12:15], s47 offen offset:2048 lds
    buffer_load_dwordx4 v227, s[12:15], s47 offen offset:3072 lds
    s_add_u32 m0, s3, 4096
    s_nop 0
    buffer_load_dwordx4 v228, s[12:15], s47 offen offset:0 lds
    s_add_u32 s47, s47, 40960
    s_waitcnt vmcnt(24)
    s_barrier
    s_mov_b32 m0, s54
    s_add_u32 s54, s54, 12288
    buffer_load_dwordx4 v229, s[8:11], s52 offen lds
    s_add_u32 m0, m0, 1024
    s_mov_b32 exec_lo, 65535
    s_mov_b32 exec_hi, 4279238655
    buffer_load_dwordx4 v230, s[8:11], s52 offen lds
    s_add_u32 m0, m0, 1024
    s_mov_b32 exec_lo, 4294905855
    s_mov_b32 exec_hi, 268435215
    buffer_load_dwordx4 v231, s[8:11], s52 offen lds
    s_mov_b64 exec, -1
    s_add_u32 s52, s52, 10240
    s_cmp_eq_u32 s54, s30
    s_cselect_b32 s38, 49152, 0
    s_sub_u32 s54, s54, s38
    s_add_u32 s3, s49, 0
    s_add_u32 m0, s3, 0
    s_nop 0
    buffer_load_dwordx4 v224, s[12:15], s47 offen offset:0 lds
    buffer_load_dwordx4 v225, s[12:15], s47 offen offset:1024 lds
    buffer_load_dwordx4 v226, s[12:15], s47 offen offset:2048 lds
    buffer_load_dwordx4 v227, s[12:15], s47 offen offset:3072 lds
    s_add_u32 m0, s3, 4096
    s_nop 0
    buffer_load_dwordx4 v228, s[12:15], s47 offen offset:0 lds
    s_add_u32 s47, s47, 40960
    v_mov_b32 v206, 1
    v_mov_b32 v200, 162312
    s_waitcnt vmcnt(13)
    s_mov_b64 exec, 1
    ds_add_rtn_u32 v200, v200, v206
    s_waitcnt lgkmcnt(0)
    v_readfirstlane_b32 s3, v200
    s_cmp_lg_u32 s3, 3
    s_cbranch_scc1 L_b_nohf
    s_cmp_lg_u32 s35, 3
    s_cbranch_scc1 L_b_nohf
    buffer_store_dword v206, v207, s[20:23], 0 offen sc1
L_b_nohf:
    s_mov_b64 exec, -1
    s_add_u32 s3, s49, 9216
    s_add_u32 m0, s3, 0
    s_nop 0
    buffer_load_dwordx4 v224, s[12:15], s47 offen offset:0 lds
    buffer_load_dwordx4 v225, s[12:15], s47 offen offset:1024 lds
    buffer_load_dwordx4 v226, s[12:15], s47 offen offset:2048 lds
    buffer_load_dwordx4 v227, s[12:15], s47 offen offset:3072 lds
    s_add_u32 m0, s3, 4096
    s_nop 0
    buffer_load_dwordx4 v228, s[12:15], s47 offen offset:0 lds
    s_add_u32 s47, s47, 40960
    s_barrier
    s_mov_b32 m0, s54
    s_add_u32 s54, s54, 12288
    buffer_load_dwordx4 v229, s[8:11], s52 offen lds
    s_add_u32 m0, m0, 1024
    s_mov_b32 exec_lo, 65535
    s_mov_b32 exec_hi, 4279238655
    buffer_load_dwordx4 v230, s[8:11], s52 offen lds
    s_add_u32 m0, m0, 1024
    s_mov_b32 exec_lo, 4294905855
    s_mov_b32 exec_hi, 268435215
    buffer_load_dwordx4 v231, s[8:11], s52 offen lds
    s_mov_b64 exec, -1
    s_add_u32 s52, s52, 10240
    s_cmp_eq_u32 s54, s30
    s_cselect_b32 s38, 49152, 0
    s_sub_u32 s54, s54, s38
    s_mov_b32 exec_lo, 16383
    s_mov_b32 exec_hi, 0
    s_mov_b32 s53, 0
L_poll_h_5:
    buffer_load_dword v206, v205, s[20:23], 0 offen sc1
    s_add_u32 s53, s53, 1
    s_waitcnt vmcnt(0)
    v_cmp_gt_u32 vcc, 1, v206
    s_cmp_gt_u32 s53, 32768
    s_cbranch_scc1 L_polled_h_6
    s_cbranch_vccz L_polled_h_6
    s_sleep 1
    s_branch L_poll_h_5
L_polled_h_6:
    s_mov_b64 exec, -1
    s_add_u32 s3, s49, 18432
    s_add_u32 m0, s3, 5120
    s_nop 0
    buffer_load_dwordx4 v232, s[16:19], s48 offen offset:0 lds
    buffer_load_dwordx4 v232, s[16:19], s48 offen offset:1024 lds
    s_add_u32 m0, s3, 7168
    s_nop 0
    buffer_load_dwordx4 v233, s[16:19], s48 offen offset:0 lds
    buffer_load_dwordx4 v233, s[16:19], s48 offen offset:1024 lds
    s_add_u32 s48, s48, 2048
    s_add_u32 s3, s49, 0
    s_add_u32 m0, s3, 5120
    s_nop 0
    buffer_load_dwordx4 v232, s[16:19], s48 offen offset:0 lds
    buffer_load_dwordx4 v232, s[16:19], s48 offen offset:1024 lds
    s_add_u32 m0, s3, 7168
    s_nop 0
    buffer_load_dwordx4 v233, s[16:19], s48 offen offset:0 lds
    buffer_load_dwordx4 v233, s[16:19], s48 offen offset:1024 lds
    s_add_u32 s48, s48, 2048
    s_add_u32 s3, s49, 9216
    s_add_u32 m0, s3, 5120
    s_nop 0
    buffer_load_dwordx4 v232, s[16:19], s48 offen offset:0 lds
    buffer_load_dwordx4 v232, s[16:19], s48 offen offset:1024 lds
    s_add_u32 m0, s3, 7168
    s_nop 0
    buffer_load_dwordx4 v233, s[16:19], s48 offen offset:0 lds
    buffer_load_dwordx4 v233, s[16:19], s48 offen offset:1024 lds
    s_add_u32 s48, s48, 2048
    s_waitcnt lgkmcnt(0)
    s_barrier
    s_mov_b32 m0, s54
    s_add_u32 s54, s54, 12288
    buffer_load_dwordx4 v229, s[8:11], s52 offen lds
    s_add_u32 m0, m0, 1024
    s_mov_b32 exec_lo, 65535
    s_mov_b32 exec_hi, 4279238655
    buffer_load_dwordx4 v230, s[8:11], s52 offen lds
    s_add_u32 m0, m0, 1024
    s_mov_b32 exec_lo, 4294905855
    s_mov_b32 exec_hi, 268435215
    buffer_load_dwordx4 v231, s[8:11], s52 offen lds
    s_mov_b64 exec, -1
    s_add_u32 s52, s52, 10240
    s_cmp_eq_u32 s54, s30
    s_cselect_b32 s38, 49152, 0
    s_sub_u32 s54, s54, s38
    s_waitcnt vmcnt(7)
    v_add_u32 v237, s51, v235
    v_add_u32 v236, s51, v234
    s_add_u32 s51, s51, 9216
    v_add_u32 v238, 128, v237
    s_cmp_eq_u32 s51, 27648
    s_cselect_b32 s51, 0, s51
    ds_read2st64_b64 v[136:139], v237 offset0:0 offset1:2
    ds_read2st64_b64 v[140:143], v238 offset0:0 offset1:2
    ds_read2st64_b64 v[144:147], v237 offset0:4 offset1:6
    ds_read2st64_b64 v[148:151], v238 offset0:4 offset1:6
    ds_read_b64_tr_b16 v[80:81], v236 offset:0
    ds_read_b64_tr_b16 v[82:83], v236 offset:2560
    ds_read_b64_tr_b16 v[84:85], v236 offset:32
    ds_read_b64_tr_b16 v[86:87], v236 offset:2592
    ds_read_b64_tr_b16 v[88:89], v236 offset:64
    ds_read_b64_tr_b16 v[90:91], v236 offset:2624
    ds_read_b64_tr_b16 v[92:93], v236 offset:96
    ds_read_b64_tr_b16 v[94:95], v236 offset:2656
    ds_read_b64_tr_b16 v[96:97], v236 offset:128
    ds_read_b64_tr_b16 v[98:99], v236 offset:2688
    s_waitcnt lgkmcnt(0)
    v_mfma_f32_16x16x32_bf16 v[0:3], v[80:83], v[136:139], v[0:3]
    v_add_u32 v237, s51, v235
    v_add_u32 v236, s51, v234
    s_add_u32 s51, s51, 9216
    v_add_u32 v238, 128, v237
    s_cmp_eq_u32 s51, 27648
    s_cselect_b32 s51, 0, s51
    ds_read2st64_b64 v[172:175], v237 offset0:0 offset1:2
    ds_read2st64_b64 v[176:179], v238 offset0:0 offset1:2
    v_mfma_f32_16x16x32_bf16 v[20:23], v[80:83], v[140:143], v[20:23]
    s_add_u32 m0, s50, 0
    s_nop 0
    buffer_load_dwordx4 v224, s[12:15], s47 offen offset:0 lds
    ds_read2st64_b64 v[180:183], v237 offset0:4 offset1:6
    v_mfma_f32_16x16x32_bf16 v[40:43], v[80:83], v[144:147], v[40:43]
    ds_read2st64_b64 v[220:223], v238 offset0:4 offset1:6
    buffer_load_dwordx4 v225, s[12:15], s47 offen offset:1024 lds
    v_mfma_f32_16x16x32_bf16 v[60:63], v[80:83], v[148:151], v[60:63]
    ds_read_b64_tr_b16 v[152:153], v236 offset:0
    v_mfma_f32_16x16x32_bf16 v[4:7], v[84:87], v[136:139], v[4:7]
    ds_read_b64_tr_b16 v[154:155], v236 offset:2560
    v_mfma_f32_16x16x32_bf16 v[24:27], v[84:87], v[140:143], v[24:27]
    buffer_load_dwordx4 v226, s[12:15], s47 offen offset:2048 lds
    v_mfma_f32_16x16x32_bf16 v[44:47], v[84:87], v[144:147], v[44:47]
    ds_read_b64_tr_b16 v[156:157], v236 offset:32
    v_mfma_f32_16x16x32_bf16 v[64:67], v[84:87], v[148:151], v[64:67]
    ds_read_b64_tr_b16 v[158:159], v236 offset:2592
    v_mfma_f32_16x16x32_bf16 v[8:11], v[88:91], v[136:139], v[8:11]
    buffer_load_dwordx4 v227, s[12:15], s47 offen offset:3072 lds
    v_mfma_f32_16x16x32_bf16 v[28:31], v[88:91], v[140:143], v[28:31]
    ds_read_b64_tr_b16 v[160:161], v236 offset:64
    v_mfma_f32_16x16x32_bf16 v[48:51], v[88:91], v[144:147], v[48:51]
    ds_read_b64_tr_b16 v[162:163], v236 offset:2624
    v_mfma_f32_16x16x32_bf16 v[68:71], v[88:91], v[148:151], v[68:71]
    s_add_u32 m0, s50, 4096
    s_nop 0
    buffer_load_dwordx4 v228, s[12:15], s47 offen offset:0 lds
    v_mfma_f32_16x16x32_bf16 v[12:15], v[92:95], v[136:139], v[12:15]
    ds_read_b64_tr_b16 v[164:165], v236 offset:96
    v_mfma_f32_16x16x32_bf16 v[32:35], v[92:95], v[140:143], v[32:35]
    ds_read_b64_tr_b16 v[166:167], v236 offset:2656
    v_mfma_f32_16x16x32_bf16 v[52:55], v[92:95], v[144:147], v[52:55]
    s_add_u32 m0, s50, 5120
    s_nop 0
    buffer_load_dwordx4 v232, s[16:19], s48 offen offset:0 lds
    v_mfma_f32_16x16x32_bf16 v[72:75], v[92:95], v[148:151], v[72:75]
    ds_read_b64_tr_b16 v[168:169], v236 offset:128
    v_mfma_f32_16x16x32_bf16 v[16:19], v[96:99], v[136:139], v[16:19]
    ds_read_b64_tr_b16 v[170:171], v236 offset:2688
    v_mfma_f32_16x16x32_bf16 v[36:39], v[96:99], v[140:143], v[36:39]
    buffer_load_dwordx4 v232, s[16:19], s48 offen offset:1024 lds
    v_mfma_f32_16x16x32_bf16 v[56:59], v[96:99], v[144:147], v[56:59]
    s_add_u32 m0, s50, 7168
    s_nop 0
    buffer_load_dwordx4 v233, s[16:19], s48 offen offset:0 lds
    v_mfma_f32_16x16x32_bf16 v[76:79], v[96:99], v[148:151], v[76:79]
    buffer_load_dwordx4 v233, s[16:19], s48 offen offset:1024 lds
    s_add_u32 s48, s48, 2048
    s_add_u32 s47, s47, 40960
    s_add_u32 s50, s50, 9216
    s_cmp_eq_u32 s50, s31
    s_cselect_b32 s50, s49, s50
    s_mov_b32 s55, 0
L_bloop:
    s_waitcnt lgkmcnt(0)
    s_barrier
    s_mov_b32 m0, s54
    s_add_u32 s54, s54, 12288
    buffer_load_dwordx4 v229, s[8:11], s52 offen lds
    s_add_u32 m0, m0, 1024
    s_mov_b32 exec_lo, 65535
    s_mov_b32 exec_hi, 4279238655
    buffer_load_dwordx4 v230, s[8:11], s52 offen lds
    s_add_u32 m0, m0, 1024
    s_mov_b32 exec_lo, 4294905855
    s_mov_b32 exec_hi, 268435215
    buffer_load_dwordx4 v231, s[8:11], s52 offen lds
    s_mov_b64 exec, -1
    s_add_u32 s52, s52, 10240
    s_cmp_eq_u32 s54, s30
    s_cselect_b32 s38, 49152, 0
    s_sub_u32 s54, s54, s38
    s_waitcnt vmcnt(12)
    v_mfma_f32_16x16x32_bf16 v[0:3], v[152:155], v[172:175], v[0:3]
    v_add_u32 v237, s51, v235
    v_add_u32 v236, s51, v234
    s_add_u32 s51, s51, 9216
    v_add_u32 v238, 128, v237
    s_cmp_eq_u32 s51, 27648
    s_cselect_b32 s51, 0, s51
    ds_read2st64_b64 v[136:139], v237 offset0:0 offset1:2
    ds_read2st64_b64 v[140:143], v238 offset0:0 offset1:2
    v_mfma_f32_16x16x32_bf16 v[20:23], v[152:155], v[176:179], v[20:23]
    s_add_u32 m0, s50, 0
    s_nop 0
    buffer_load_dwordx4 v224, s[12:15], s47 offen offset:0 lds
    ds_read2st64_b64 v[144:147], v237 offset0:4 offset1:6
    v_mfma_f32_16x16x32_bf16 v[40:43], v[152:155], v[180:183], v[40:43]
    ds_read2st64_b64 v[148:151], v238 offset0:4 offset1:6
    buffer_load_dwordx4 v225, s[12:15], s47 offen offset:1024 lds
    v_mfma_f32_16x16x32_bf16 v[60:63], v[152:155], v[220:223], v[60:63]
    ds_read_b64_tr_b16 v[80:81], v236 offset:0
    v_mfma_f32_16x16x32_bf16 v[4:7], v[156:159], v[172:175], v[4:7]
    ds_read_b64_tr_b16 v[82:83], v236 offset:2560
    v_mfma_f32_16x16x32_bf16 v[24:27], v[156:159], v[176:179], v[24:27]
    buffer_load_dwordx4 v226, s[12:15], s47 offen offset:2048 lds
    v_mfma_f32_16x16x32_bf16 v[44:47], v[156:159], v[180:183], v[44:47]
    ds_read_b64_tr_b16 v[84:85], v236 offset:32
    v_mfma_f32_16x16x32_bf16 v[64:67], v[156:159], v[220:223], v[64:67]
    ds_read_b64_tr_b16 v[86:87], v236 offset:2592
    v_mfma_f32_16x16x32_bf16 v[8:11], v[160:163], v[172:175], v[8:11]
    buffer_load_dwordx4 v227, s[12:15], s47 offen offset:3072 lds
    v_mfma_f32_16x16x32_bf16 v[28:31], v[160:163], v[176:179], v[28:31]
    ds_read_b64_tr_b16 v[88:89], v236 offset:64
    v_mfma_f32_16x16x32_bf16 v[48:51], v[160:163], v[180:183], v[48:51]
    ds_read_b64_tr_b16 v[90:91], v236 offset:2624
    v_mfma_f32_16x16x32_bf16 v[68:71], v[160:163], v[220:223], v[68:71]
    s_add_u32 m0, s50, 4096
    s_nop 0
    buffer_load_dwordx4 v228, s[12:15], s47 offen offset:0 lds
    v_mfma_f32_16x16x32_bf16 v[12:15], v[164:167], v[172:175], v[12:15]
    ds_read_b64_tr_b16 v[92:93], v236 offset:96
    v_mfma_f32_16x16x32_bf16 v[32:35], v[164:167], v[176:179], v[32:35]
    ds_read_b64_tr_b16 v[94:95], v236 offset:2656
    v_mfma_f32_16x16x32_bf16 v[52:55], v[164:167], v[180:183], v[52:55]
    s_add_u32 m0, s50, 5120
    s_nop 0
    buffer_load_dwordx4 v232, s[16:19], s48 offen offset:0 lds
    v_mfma_f32_16x16x32_bf16 v[72:75], v[164:167], v[220:223], v[72:75]
    ds_read_b64_tr_b16 v[96:97], v236 offset:128
    v_mfma_f32_16x16x32_bf16 v[16:19], v[168:171], v[172:175], v[16:19]
    ds_read_b64_tr_b16 v[98:99], v236 offset:2688
    v_mfma_f32_16x16x32_bf16 v[36:39], v[168:171], v[176:179], v[36:39]
    buffer_load_dwordx4 v232, s[16:19], s48 offen offset:1024 lds
    v_mfma_f32_16x16x32_bf16 v[56:59], v[168:171], v[180:183], v[56:59]
    s_add_u32 m0, s50, 7168
    s_nop 0
    buffer_load_dwordx4 v233, s[16:19], s48 offen offset:0 lds
    v_mfma_f32_16x16x32_bf16 v[76:79], v[168:171], v[220:223], v[76:79]
    buffer_load_dwordx4 v233, s[16:19], s48 offen offset:1024 lds
    s_add_u32 s48, s48, 2048
    s_add_u32 s47, s47, 40960
    s_add_u32 s50, s50, 9216
    s_cmp_eq_u32 s50, s31
    s_cselect_b32 s50, s49, s50
    s_waitcnt lgkmcnt(0)
    s_barrier
    s_mov_b32 m0, s54
    s_add_u32 s54, s54, 12288
    buffer_load_dwordx4 v229, s[8:11], s52 offen lds
    s_add_u32 m0, m0, 1024
    s_mov_b32 exec_lo, 65535
    s_mov_b32 exec_hi, 4279238655
    buffer_load_dwordx4 v230, s[8:11], s52 offen lds
    s_add_u32 m0, m0, 1024
    s_mov_b32 exec_lo, 4294905855
    s_mov_b32 exec_hi, 268435215
    buffer_load_dwordx4 v231, s[8:11], s52 offen lds
    s_mov_b64 exec, -1
    s_add_u32 s52, s52, 10240
    s_cmp_eq_u32 s54, s30
    s_cselect_b32 s38, 49152, 0
    s_sub_u32 s54, s54, s38
    s_waitcnt vmcnt(12)
    v_mfma_f32_16x16x32_bf16 v[0:3], v[80:83], v[136:139], v[0:3]
    v_add_u32 v237, s51, v235
    v_add_u32 v236, s51, v234
    s_add_u32 s51, s51, 9216
    v_add_u32 v238, 128, v237
    s_cmp_eq_u32 s51, 27648
    s_cselect_b32 s51, 0, s51
    ds_read2st64_b64 v[172:175], v237 offset0:0 offset1:2
    ds_read2st64_b64 v[176:179], v238 offset0:0 offset1:2
    v_mfma_f32_16x16x32_bf16 v[20:23], v[80:83], v[140:143], v[20:23]
    s_add_u32 m0, s50, 0
    s_nop 0
    buffer_load_dwordx4 v224, s[12:15], s47 offen offset:0 lds
    ds_read2st64_b64 v[180:183], v237 offset0:4 offset1:6
    v_mfma_f32_16x16x32_bf16 v[40:43], v[80:83], v[144:147], v[40:43]
    ds_read2st64_b64 v[220:223], v238 offset0:4 offset1:6
    buffer_load_dwordx4 v225, s[12:15], s47 offen offset:1024 lds
    v_mfma_f32_16x16x32_bf16 v[60:63], v[80:83], v[148:151], v[60:63]
    ds_read_b64_tr_b16 v[152:153], v236 offset:0
    v_mfma_f32_16x16x32_bf16 v[4:7], v[84:87], v[136:139], v[4:7]
    ds_read_b64_tr_b16 v[154:155], v236 offset:2560
    v_mfma_f32_16x16x32_bf16 v[24:27], v[84:87], v[140:143], v[24:27]
    buffer_load_dwordx4 v226, s[12:15], s47 offen offset:2048 lds
    v_mfma_f32_16x16x32_bf16 v[44:47], v[84:87], v[144:147], v[44:47]
    ds_read_b64_tr_b16 v[156:157], v236 offset:32
    v_mfma_f32_16x16x32_bf16 v[64:67], v[84:87], v[148:151], v[64:67]
    ds_read_b64_tr_b16 v[158:159], v236 offset:2592
    v_mfma_f32_16x16x32_bf16 v[8:11], v[88:91], v[136:139], v[8:11]
    buffer_load_dwordx4 v227, s[12:15], s47 offen offset:3072 lds
    v_mfma_f32_16x16x32_bf16 v[28:31], v[88:91], v[140:143], v[28:31]
    ds_read_b64_tr_b16 v[160:161], v236 offset:64
    v_mfma_f32_16x16x32_bf16 v[48:51], v[88:91], v[144:147], v[48:51]
    ds_read_b64_tr_b16 v[162:163], v236 offset:2624
    v_mfma_f32_16x16x32_bf16 v[68:71], v[88:91], v[148:151], v[68:71]
    s_add_u32 m0, s50, 4096
    s_nop 0
    buffer_load_dwordx4 v228, s[12:15], s47 offen offset:0 lds
    v_mfma_f32_16x16x32_bf16 v[12:15], v[92:95], v[136:139], v[12:15]
    ds_read_b64_tr_b16 v[164:165], v236 offset:96
    v_mfma_f32_16x16x32_bf16 v[32:35], v[92:95], v[140:143], v[32:35]
    ds_read_b64_tr_b16 v[166:167], v236 offset:2656
    v_mfma_f32_16x16x32_bf16 v[52:55], v[92:95], v[144:147], v[52:55]
    s_add_u32 m0, s50, 5120
    s_nop 0
    buffer_load_dwordx4 v232, s[16:19], s48 offen offset:0 lds
    v_mfma_f32_16x16x32_bf16 v[72:75], v[92:95], v[148:151], v[72:75]
    ds_read_b64_tr_b16 v[168:169], v236 offset:128
    v_mfma_f32_16x16x32_bf16 v[16:19], v[96:99], v[136:139], v[16:19]
    ds_read_b64_tr_b16 v[170:171], v236 offset:2688
    v_mfma_f32_16x16x32_bf16 v[36:39], v[96:99], v[140:143], v[36:39]
    buffer_load_dwordx4 v232, s[16:19], s48 offen offset:1024 lds
    v_mfma_f32_16x16x32_bf16 v[56:59], v[96:99], v[144:147], v[56:59]
    s_add_u32 m0, s50, 7168
    s_nop 0
    buffer_load_dwordx4 v233, s[16:19], s48 offen offset:0 lds
    v_mfma_f32_16x16x32_bf16 v[76:79], v[96:99], v[148:151], v[76:79]
    buffer_load_dwordx4 v233, s[16:19], s48 offen offset:1024 lds
    s_add_u32 s48, s48, 2048
    s_add_u32 s47, s47, 40960
    s_add_u32 s50, s50, 9216
    s_cmp_eq_u32 s50, s31
    s_cselect_b32 s50, s49, s50
    s_add_u32 s55, s55, 1
    s_cmp_lt_u32 s55, 4
    s_cbranch_scc1 L_bloop
    s_waitcnt lgkmcnt(0)
    s_barrier
    s_mov_b32 m0, s54
    s_add_u32 s54, s54, 12288
    buffer_load_dwordx4 v229, s[8:11], s52 offen lds
    s_add_u32 m0, m0, 1024
    s_mov_b32 exec_lo, 65535
    s_mov_b32 exec_hi, 4279238655
    buffer_load_dwordx4 v230, s[8:11], s52 offen lds
    s_add_u32 m0, m0, 1024
    s_mov_b32 exec_lo, 4294905855
    s_mov_b32 exec_hi, 268435215
    buffer_load_dwordx4 v231, s[8:11], s52 offen lds
    s_mov_b64 exec, -1
    s_add_u32 s52, s52, 10240
    s_cmp_eq_u32 s54, s30
    s_cselect_b32 s38, 49152, 0
    s_sub_u32 s54, s54, s38
    s_waitcnt vmcnt(12)
    v_mfma_f32_16x16x32_bf16 v[0:3], v[152:155], v[172:175], v[0:3]
    v_add_u32 v237, s51, v235
    v_add_u32 v236, s51, v234
    s_add_u32 s51, s51, 9216
    v_add_u32 v238, 128, v237
    s_cmp_eq_u32 s51, 27648
    s_cselect_b32 s51, 0, s51
    ds_read2st64_b64 v[136:139], v237 offset0:0 offset1:2
    ds_read2st64_b64 v[140:143], v238 offset0:0 offset1:2
    v_mfma_f32_16x16x32_bf16 v[20:23], v[152:155], v[176:179], v[20:23]
    s_add_u32 m0, s50, 0
    s_nop 0
    buffer_load_dwordx4 v224, s[12:15], s47 offen offset:0 lds
    ds_read2st64_b64 v[144:147], v237 offset0:4 offset1:6
    v_mfma_f32_16x16x32_bf16 v[40:43], v[152:155], v[180:183], v[40:43]
    ds_read2st64_b64 v[148:151], v238 offset0:4 offset1:6
    buffer_load_dwordx4 v225, s[12:15], s47 offen offset:1024 lds
    v_mfma_f32_16x16x32_bf16 v[60:63], v[152:155], v[220:223], v[60:63]
    ds_read_b64_tr_b16 v[80:81], v236 offset:0
    v_mfma_f32_16x16x32_bf16 v[4:7], v[156:159], v[172:175], v[4:7]
    ds_read_b64_tr_b16 v[82:83], v236 offset:2560
    v_mfma_f32_16x16x32_bf16 v[24:27], v[156:159], v[176:179], v[24:27]
    buffer_load_dwordx4 v226, s[12:15], s47 offen offset:2048 lds
    v_mfma_f32_16x16x32_bf16 v[44:47], v[156:159], v[180:183], v[44:47]
    ds_read_b64_tr_b16 v[84:85], v236 offset:32
    v_mfma_f32_16x16x32_bf16 v[64:67], v[156:159], v[220:223], v[64:67]
    ds_read_b64_tr_b16 v[86:87], v236 offset:2592
    v_mfma_f32_16x16x32_bf16 v[8:11], v[160:163], v[172:175], v[8:11]
    buffer_load_dwordx4 v227, s[12:15], s47 offen offset:3072 lds
    v_mfma_f32_16x16x32_bf16 v[28:31], v[160:163], v[176:179], v[28:31]
    ds_read_b64_tr_b16 v[88:89], v236 offset:64
    v_mfma_f32_16x16x32_bf16 v[48:51], v[160:163], v[180:183], v[48:51]
    ds_read_b64_tr_b16 v[90:91], v236 offset:2624
    v_mfma_f32_16x16x32_bf16 v[68:71], v[160:163], v[220:223], v[68:71]
    s_add_u32 m0, s50, 4096
    s_nop 0
    buffer_load_dwordx4 v228, s[12:15], s47 offen offset:0 lds
    v_mfma_f32_16x16x32_bf16 v[12:15], v[164:167], v[172:175], v[12:15]
    ds_read_b64_tr_b16 v[92:93], v236 offset:96
    v_mfma_f32_16x16x32_bf16 v[32:35], v[164:167], v[176:179], v[32:35]
    ds_read_b64_tr_b16 v[94:95], v236 offset:2656
    v_mfma_f32_16x16x32_bf16 v[52:55], v[164:167], v[180:183], v[52:55]
    s_add_u32 m0, s50, 5120
    s_nop 0
    buffer_load_dwordx4 v232, s[16:19], s48 offen offset:0 lds
    v_mfma_f32_16x16x32_bf16 v[72:75], v[164:167], v[220:223], v[72:75]
    ds_read_b64_tr_b16 v[96:97], v236 offset:128
    v_mfma_f32_16x16x32_bf16 v[16:19], v[168:171], v[172:175], v[16:19]
    ds_read_b64_tr_b16 v[98:99], v236 offset:2688
    v_mfma_f32_16x16x32_bf16 v[36:39], v[168:171], v[176:179], v[36:39]
    buffer_load_dwordx4 v232, s[16:19], s48 offen offset:1024 lds
    v_mfma_f32_16x16x32_bf16 v[56:59], v[168:171], v[180:183], v[56:59]
    s_add_u32 m0, s50, 7168
    s_nop 0
    buffer_load_dwordx4 v233, s[16:19], s48 offen offset:0 lds
    v_mfma_f32_16x16x32_bf16 v[76:79], v[168:171], v[220:223], v[76:79]
    buffer_load_dwordx4 v233, s[16:19], s48 offen offset:1024 lds
    s_add_u32 s48, s48, 2048
    s_add_u32 s47, s47, 40960
    s_add_u32 s50, s50, 9216
    s_cmp_eq_u32 s50, s31
    s_cselect_b32 s50, s49, s50
    s_waitcnt lgkmcnt(0)
    s_barrier
    s_waitcnt vmcnt(9)
    v_add_u32 v237, s51, v235
    v_add_u32 v236, s51, v234
    s_add_u32 s51, s51, 9216
    v_add_u32 v238, 128, v237
    s_cmp_eq_u32 s51, 27648
    s_cselect_b32 s51, 0, s51
    ds_read2st64_b64 v[172:175], v237 offset0:0 offset1:2
    ds_read2st64_b64 v[176:179], v238 offset0:0 offset1:2
    s_add_u32 m0, s50, 0
    s_nop 0
    buffer_load_dwordx4 v224, s[12:15], s47 offen offset:0 lds
    ds_read2st64_b64 v[180:183], v237 offset0:4 offset1:6
    ds_read2st64_b64 v[220:223], v238 offset0:4 offset1:6
    buffer_load_dwordx4 v225, s[12:15], s47 offen offset:1024 lds
    ds_read_b64_tr_b16 v[152:153], v236 offset:0
    ds_read_b64_tr_b16 v[154:155], v236 offset:2560
    buffer_load_dwordx4 v226, s[12:15], s47 offen offset:2048 lds
    ds_read_b64_tr_b16 v[156:157], v236 offset:32
    ds_read_b64_tr_b16 v[158:159], v236 offset:2592
    buffer_load_dwordx4 v227, s[12:15], s47 offen offset:3072 lds
    ds_read_b64_tr_b16 v[160:161], v236 offset:64
    ds_read_b64_tr_b16 v[162:163], v236 offset:2624
    s_add_u32 m0, s50, 4096
    s_nop 0
    buffer_load_dwordx4 v228, s[12:15], s47 offen offset:0 lds
    s_cmp_ge_u32 s44, 2
    s_cselect_b32 s48, 0x40000000, s48
    ds_read_b64_tr_b16 v[164:165], v236 offset:96
    ds_read_b64_tr_b16 v[166:167], v236 offset:2656
    s_add_u32 m0, s50, 5120
    s_nop 0
    buffer_load_dwordx4 v232, s[16:19], s48 offen offset:0 lds
    ds_read_b64_tr_b16 v[168:169], v236 offset:128
    ds_read_b64_tr_b16 v[170:171], v236 offset:2688
    buffer_load_dwordx4 v232, s[16:19], s48 offen offset:1024 lds
    s_add_u32 m0, s50, 7168
    s_nop 0
    buffer_load_dwordx4 v233, s[16:19], s48 offen offset:0 lds
    buffer_load_dwordx4 v233, s[16:19], s48 offen offset:1024 lds
    s_add_u32 s48, s48, 2048
    s_add_u32 s47, s47, 40960
    s_add_u32 s50, s50, 9216
    s_cmp_eq_u32 s50, s31
    s_cselect_b32 s50, s49, s50
    s_waitcnt vmcnt(9)
    v_add_u32 v237, s51, v235
    v_add_u32 v236, s51, v234
    s_add_u32 s51, s51, 9216
    v_add_u32 v238, 128, v237
    s_cmp_eq_u32 s51, 27648
    s_cselect_b32 s51, 0, s51
    ds_read2st64_b64 v[204:207], v237 offset0:0 offset1:2
    ds_read2st64_b64 v[208:211], v238 offset0:0 offset1:2
    ds_read2st64_b64 v[212:215], v237 offset0:4 offset1:6
    ds_read2st64_b64 v[216:219], v238 offset0:4 offset1:6
    ds_read_b64_tr_b16 v[184:185], v236 offset:0
    ds_read_b64_tr_b16 v[186:187], v236 offset:2560
    ds_read_b64_tr_b16 v[188:189], v236 offset:32
    ds_read_b64_tr_b16 v[190:191], v236 offset:2592
    ds_read_b64_tr_b16 v[192:193], v236 offset:64
    ds_read_b64_tr_b16 v[194:195], v236 offset:2624
    ds_read_b64_tr_b16 v[196:197], v236 offset:96
    ds_read_b64_tr_b16 v[198:199], v236 offset:2656
    ds_read_b64_tr_b16 v[200:201], v236 offset:128
    ds_read_b64_tr_b16 v[202:203], v236 offset:2688
    s_waitcnt lgkmcnt(14)
    s_mov_b32 s12, s40
    s_mov_b32 s13, s41
    s_mov_b32 s14, 819200
    s_mov_b32 s15, 0x20000
    s_mul_i32 s48, s44, 204800
    s_mul_i32 s38, s46, 160
    s_add_u32 s48, s48, s38
    s_add_u32 s47, s48, 81920
    s_add_u32 s50, s49, 12288
    s_add_u32 m0, s50, 0
    s_nop 0
    buffer_load_dwordx4 v224, s[12:15], s47 offen offset:0 lds
    buffer_load_dwordx4 v225, s[12:15], s47 offen offset:1024 lds
    buffer_load_dwordx4 v226, s[12:15], s47 offen offset:2048 lds
    buffer_load_dwordx4 v227, s[12:15], s47 offen offset:3072 lds
    s_add_u32 m0, s50, 4096
    s_nop 0
    buffer_load_dwordx4 v228, s[12:15], s47 offen offset:0 lds
    s_waitcnt lgkmcnt(0)
    s_barrier
    s_waitcnt vmcnt(5)
    v_add_u32 v237, s51, v235
    v_add_u32 v236, s51, v234
    s_add_u32 s51, s51, 9216
    v_add_u32 v238, 128, v237
    s_cmp_eq_u32 s51, 27648
    s_cselect_b32 s51, 0, s51
    ds_read2st64_b64 v[120:123], v237 offset0:0 offset1:2
    ds_read2st64_b64 v[124:127], v238 offset0:0 offset1:2
    s_add_u32 s47, s48, 122880
    s_add_u32 s50, s49, 17408
    s_add_u32 m0, s50, 0
    s_nop 0
    buffer_load_dwordx4 v224, s[12:15], s47 offen offset:0 lds
    ds_read2st64_b64 v[128:131], v237 offset0:4 offset1:6
    ds_read2st64_b64 v[132:135], v238 offset0:4 offset1:6
    buffer_load_dwordx4 v225, s[12:15], s47 offen offset:1024 lds
    ds_read_b64_tr_b16 v[100:101], v236 offset:0
    ds_read_b64_tr_b16 v[102:103], v236 offset:2560
    buffer_load_dwordx4 v226, s[12:15], s47 offen offset:2048 lds
    ds_read_b64_tr_b16 v[104:105], v236 offset:32
    ds_read_b64_tr_b16 v[106:107], v236 offset:2592
    buffer_load_dwordx4 v227, s[12:15], s47 offen offset:3072 lds
    ds_read_b64_tr_b16 v[108:109], v236 offset:64
    ds_read_b64_tr_b16 v[110:111], v236 offset:2624
    s_add_u32 m0, s50, 4096
    s_nop 0
    buffer_load_dwordx4 v228, s[12:15], s47 offen offset:0 lds
    ds_read_b64_tr_b16 v[112:113], v236 offset:96
    ds_read_b64_tr_b16 v[114:115], v236 offset:2656
    s_add_u32 s47, s48, 163840
    s_add_u32 s50, s49, 22528
    s_add_u32 m0, s50, 0
    s_nop 0
    buffer_load_dwordx4 v224, s[12:15], s47 offen offset:0 lds
    ds_read_b64_tr_b16 v[116:117], v236 offset:128
    ds_read_b64_tr_b16 v[118:119], v236 offset:2688
    buffer_load_dwordx4 v225, s[12:15], s47 offen offset:1024 lds
    buffer_load_dwordx4 v226, s[12:15], s47 offen offset:2048 lds
    buffer_load_dwordx4 v227, s[12:15], s47 offen offset:3072 lds
    s_add_u32 m0, s50, 4096
    s_nop 0
    buffer_load_dwordx4 v228, s[12:15], s47 offen offset:0 lds
    s_waitcnt lgkmcnt(0)
    s_barrier
    s_add_u32 s47, s48, 0
    s_add_u32 s50, s49, 2048
    s_add_u32 m0, s50, 0
    s_nop 0
    buffer_load_dwordx4 v224, s[12:15], s47 offen offset:0 lds
    buffer_load_dwordx4 v225, s[12:15], s47 offen offset:1024 lds
    buffer_load_dwordx4 v226, s[12:15], s47 offen offset:2048 lds
    buffer_load_dwordx4 v227, s[12:15], s47 offen offset:3072 lds
    s_add_u32 m0, s50, 4096
    s_nop 0
    buffer_load_dwordx4 v228, s[12:15], s47 offen offset:0 lds
    s_add_u32 s47, s48, 40960
    s_add_u32 s50, s49, 7168
    s_add_u32 m0, s50, 0
    s_nop 0
    buffer_load_dwordx4 v224, s[12:15], s47 offen offset:0 lds
    buffer_load_dwordx4 v225, s[12:15], s47 offen offset:1024 lds
    buffer_load_dwordx4 v226, s[12:15], s47 offen offset:2048 lds
    buffer_load_dwordx4 v227, s[12:15], s47 offen offset:3072 lds
    s_add_u32 m0, s50, 4096
    s_nop 0
    buffer_load_dwordx4 v228, s[12:15], s47 offen offset:0 lds
    s_add_u32 s16, s42, 14974976
    s_addc_u32 s17, s43, 0
    s_mov_b32 s18, 2637824
    s_mov_b32 s19, 0x20000
    s_mul_i32 s48, s45, 82432
    s_mul_i32 s38, s44, 10240
    s_add_u32 s48, s48, s38
    s_mov_b32 s8, s4
    s_mov_b32 s9, s5
    s_mov_b32 s10, 2621440
    s_mov_b32 s11, 0x20000
    s_mov_b32 s12, s60
    s_mov_b32 s13, s61
    s_mov_b32 s14, 2621440
    s_mov_b32 s15, 0x20000
    s_mul_i32 s55, s45, 81920
    s_mul_i32 s38, s46, 160
    s_add_u32 s55, s55, s38
    buffer_load_dwordx2 v[234:235], v245, s[8:11], s55 offen
    buffer_load_dwordx2 v[236:237], v246, s[8:11], s55 offen
    v_mov_b32 v248, 162304
    s_mov_b32 s53, 0
L_lw_o_7:
    ds_read_b32 v249, v248
    s_add_u32 s53, s53, 1
    s_waitcnt lgkmcnt(0)
    v_cmp_gt_u32 vcc, 4, v249
    s_cmp_gt_u32 s53, 131072
    s_cbranch_scc1 L_lwd_o_8
    s_cbranch_vccz L_lwd_o_8
    s_sleep 1
    s_branch L_lw_o_7
L_lwd_o_8:
    s_setprio 1
    v_mfma_f32_16x16x32_bf16 v[0:3], v[80:83], v[136:139], v[0:3]
    v_mfma_f32_16x16x32_bf16 v[20:23], v[80:83], v[140:143], v[20:23]
    v_mfma_f32_16x16x32_bf16 v[40:43], v[80:83], v[144:147], v[40:43]
    v_mfma_f32_16x16x32_bf16 v[60:63], v[80:83], v[148:151], v[60:63]
    v_mfma_f32_16x16x32_bf16 v[4:7], v[84:87], v[136:139], v[4:7]
    v_mfma_f32_16x16x32_bf16 v[24:27], v[84:87], v[140:143], v[24:27]
    v_mfma_f32_16x16x32_bf16 v[44:47], v[84:87], v[144:147], v[44:47]
    v_mfma_f32_16x16x32_bf16 v[64:67], v[84:87], v[148:151], v[64:67]
    v_mfma_f32_16x16x32_bf16 v[8:11], v[88:91], v[136:139], v[8:11]
    v_mfma_f32_16x16x32_bf16 v[28:31], v[88:91], v[140:143], v[28:31]
    v_mfma_f32_16x16x32_bf16 v[48:51], v[88:91], v[144:147], v[48:51]
    v_mfma_f32_16x16x32_bf16 v[68:71], v[88:91], v[148:151], v[68:71]
    v_mfma_f32_16x16x32_bf16 v[12:15], v[92:95], v[136:139], v[12:15]
    v_mfma_f32_16x16x32_bf16 v[32:35], v[92:95], v[140:143], v[32:35]
    v_mfma_f32_16x16x32_bf16 v[52:55], v[92:95], v[144:147], v[52:55]
    v_mfma_f32_16x16x32_bf16 v[72:75], v[92:95], v[148:151], v[72:75]
    v_mfma_f32_16x16x32_bf16 v[16:19], v[96:99], v[136:139], v[16:19]
    v_mfma_f32_16x16x32_bf16 v[36:39], v[96:99], v[140:143], v[36:39]
    v_mfma_f32_16x16x32_bf16 v[56:59], v[96:99], v[144:147], v[56:59]
    v_mfma_f32_16x16x32_bf16 v[76:79], v[96:99], v[148:151], v[76:79]
    buffer_load_dword v226, v244, s[16:19], 0 offen sc1
    v_mfma_f32_16x16x32_bf16 v[0:3], v[152:155], v[172:175], v[0:3]
    v_mfma_f32_16x16x32_bf16 v[20:23], v[152:155], v[176:179], v[20:23]
    v_mfma_f32_16x16x32_bf16 v[40:43], v[152:155], v[180:183], v[40:43]
    v_mfma_f32_16x16x32_bf16 v[60:63], v[152:155], v[220:223], v[60:63]
    v_mfma_f32_16x16x32_bf16 v[4:7], v[156:159], v[172:175], v[4:7]
    v_mfma_f32_16x16x32_bf16 v[24:27], v[156:159], v[176:179], v[24:27]
    v_mfma_f32_16x16x32_bf16 v[44:47], v[156:159], v[180:183], v[44:47]
    v_mfma_f32_16x16x32_bf16 v[64:67], v[156:159], v[220:223], v[64:67]
    v_mfma_f32_16x16x32_bf16 v[8:11], v[160:163], v[172:175], v[8:11]
    v_mfma_f32_16x16x32_bf16 v[28:31], v[160:163], v[176:179], v[28:31]
    v_mfma_f32_16x16x32_bf16 v[48:51], v[160:163], v[180:183], v[48:51]
    v_mfma_f32_16x16x32_bf16 v[68:71], v[160:163], v[220:223], v[68:71]
    v_mfma_f32_16x16x32_bf16 v[12:15], v[164:167], v[172:175], v[12:15]
    v_mfma_f32_16x16x32_bf16 v[32:35], v[164:167], v[176:179], v[32:35]
    v_mfma_f32_16x16x32_bf16 v[52:55], v[164:167], v[180:183], v[52:55]
    v_mfma_f32_16x16x32_bf16 v[72:75], v[164:167], v[220:223], v[72:75]
    v_mfma_f32_16x16x32_bf16 v[16:19], v[168:171], v[172:175], v[16:19]
    v_mfma_f32_16x16x32_bf16 v[36:39], v[168:171], v[176:179], v[36:39]
    v_mfma_f32_16x16x32_bf16 v[56:59], v[168:171], v[180:183], v[56:59]
    v_mfma_f32_16x16x32_bf16 v[76:79], v[168:171], v[220:223], v[76:79]
    s_waitcnt vmcnt(1)
    ds_read_b64_tr_b16 v[80:81], v239 offset:0
    ds_read_b64_tr_b16 v[82:83], v239 offset:1280
    ds_read_b64_tr_b16 v[84:85], v239 offset:32
    ds_read_b64_tr_b16 v[86:87], v239 offset:1312
    ds_read_b64_tr_b16 v[88:89], v239 offset:64
    ds_read_b64_tr_b16 v[90:91], v239 offset:1344
    ds_read_b64_tr_b16 v[92:93], v239 offset:96
    ds_read_b64_tr_b16 v[94:95], v239 offset:1376
    ds_read_b64_tr_b16 v[96:97], v239 offset:128
    ds_read_b64_tr_b16 v[98:99], v239 offset:1408
    s_waitcnt vmcnt(0)
    v_cmp_eq_u32 vcc, -1, v226
    s_nop 4
    s_cbranch_vccz L_opolled
    s_mov_b32 exec_lo, 65535
    s_mov_b32 exec_hi, 0
    s_mov_b32 s53, 0
L_poll_os_9:
    buffer_load_dword v226, v244, s[16:19], 0 offen sc1
    s_add_u32 s53, s53, 1
    s_waitcnt vmcnt(0)
    v_cmp_eq_u32 vcc, -1, v226
    s_cmp_gt_u32 s53, 32768
    s_cbranch_scc1 L_polled_os_10
    s_cbranch_vccz L_polled_os_10
    s_sleep 1
    s_branch L_poll_os_9
L_polled_os_10:
    s_mov_b64 exec, -1
L_opolled:
    s_add_u32 s3, s48, 0
    buffer_load_dwordx4 v[136:139], v241, s[16:19], s3 offen offset:0 sc1
    buffer_load_dwordx4 v[140:143], v241, s[16:19], s3 offen offset:256 sc1
    s_add_u32 s3, s48, 41216
    buffer_load_dwordx4 v[144:147], v241, s[16:19], s3 offen offset:0 sc1
    buffer_load_dwordx4 v[148:151], v241, s[16:19], s3 offen offset:256 sc1
    s_add_u32 s3, s48, 2560
    buffer_load_dwordx4 v[152:155], v241, s[16:19], s3 offen offset:0 sc1
    buffer_load_dwordx4 v[156:159], v241, s[16:19], s3 offen offset:256 sc1
    s_add_u32 s3, s48, 43776
    buffer_load_dwordx4 v[160:163], v241, s[16:19], s3 offen offset:0 sc1
    buffer_load_dwordx4 v[164:167], v241, s[16:19], s3 offen offset:256 sc1
    s_add_u32 s3, s48, 5120
    buffer_load_dwordx4 v[168:171], v241, s[16:19], s3 offen offset:0 sc1
    buffer_load_dwordx4 v[172:175], v241, s[16:19], s3 offen offset:256 sc1
    s_add_u32 s3, s48, 46336
    buffer_load_dwordx4 v[176:179], v241, s[16:19], s3 offen offset:0 sc1
    buffer_load_dwordx4 v[180:183], v241, s[16:19], s3 offen offset:256 sc1
    v_mfma_f32_16x16x32_bf16 v[0:3], v[184:187], v[204:207], v[0:3]
    v_mfma_f32_16x16x32_bf16 v[20:23], v[184:187], v[208:211], v[20:23]
    v_mfma_f32_16x16x32_bf16 v[40:43], v[184:187], v[212:215], v[40:43]
    v_mfma_f32_16x16x32_bf16 v[60:63], v[184:187], v[216:219], v[60:63]
    v_mfma_f32_16x16x32_bf16 v[4:7], v[188:191], v[204:207], v[4:7]
    v_mfma_f32_16x16x32_bf16 v[24:27], v[188:191], v[208:211], v[24:27]
    v_mfma_f32_16x16x32_bf16 v[44:47], v[188:191], v[212:215], v[44:47]
    v_mfma_f32_16x16x32_bf16 v[64:67], v[188:191], v[216:219], v[64:67]
    v_mfma_f32_16x16x32_bf16 v[8:11], v[192:195], v[204:207], v[8:11]
    v_mfma_f32_16x16x32_bf16 v[28:31], v[192:195], v[208:211], v[28:31]
    v_mfma_f32_16x16x32_bf16 v[48:51], v[192:195], v[212:215], v[48:51]
    v_mfma_f32_16x16x32_bf16 v[68:71], v[192:195], v[216:219], v[68:71]
    v_mfma_f32_16x16x32_bf16 v[12:15], v[196:199], v[204:207], v[12:15]
    v_mfma_f32_16x16x32_bf16 v[32:35], v[196:199], v[208:211], v[32:35]
    v_mfma_f32_16x16x32_bf16 v[52:55], v[196:199], v[212:215], v[52:55]
    v_mfma_f32_16x16x32_bf16 v[72:75], v[196:199], v[216:219], v[72:75]
    v_mfma_f32_16x16x32_bf16 v[16:19], v[200:203], v[204:207], v[16:19]
    v_mfma_f32_16x16x32_bf16 v[36:39], v[200:203], v[208:211], v[36:39]
    v_mfma_f32_16x16x32_bf16 v[56:59], v[200:203], v[212:215], v[56:59]
    v_mfma_f32_16x16x32_bf16 v[76:79], v[200:203], v[216:219], v[76:79]
    s_add_u32 s3, s48, 7680
    buffer_load_dwordx4 v[184:187], v241, s[16:19], s3 offen offset:0 sc1
    buffer_load_dwordx4 v[188:191], v241, s[16:19], s3 offen offset:256 sc1
    s_add_u32 s3, s48, 48896
    buffer_load_dwordx4 v[192:195], v241, s[16:19], s3 offen offset:0 sc1
    buffer_load_dwordx4 v[196:199], v241, s[16:19], s3 offen offset:256 sc1
    s_add_u32 s3, s48, 1024
    buffer_load_dwordx2 v[200:201], v242, s[16:19], s3 offen offset:0 sc1
    buffer_load_dwordx2 v[202:203], v242, s[16:19], s3 offen offset:1280 sc1
    buffer_load_dwordx2 v[204:205], v242, s[16:19], s3 offen offset:128 sc1
    buffer_load_dwordx2 v[206:207], v242, s[16:19], s3 offen offset:1408 sc1
    s_add_u32 s3, s48, 42240
    buffer_load_dwordx2 v[208:209], v242, s[16:19], s3 offen offset:0 sc1
    buffer_load_dwordx2 v[210:211], v242, s[16:19], s3 offen offset:1280 sc1
    buffer_load_dwordx2 v[212:213], v242, s[16:19], s3 offen offset:128 sc1
    buffer_load_dwordx2 v[214:215], v242, s[16:19], s3 offen offset:1408 sc1
    v_mfma_f32_16x16x32_bf16 v[0:3], v[100:103], v[120:123], v[0:3]
    v_mfma_f32_16x16x32_bf16 v[20:23], v[100:103], v[124:127], v[20:23]
    v_mfma_f32_16x16x32_bf16 v[40:43], v[100:103], v[128:131], v[40:43]
    v_mfma_f32_16x16x32_bf16 v[60:63], v[100:103], v[132:135], v[60:63]
    v_mfma_f32_16x16x32_bf16 v[4:7], v[104:107], v[120:123], v[4:7]
    v_mfma_f32_16x16x32_bf16 v[24:27], v[104:107], v[124:127], v[24:27]
    v_mfma_f32_16x16x32_bf16 v[44:47], v[104:107], v[128:131], v[44:47]
    v_mfma_f32_16x16x32_bf16 v[64:67], v[104:107], v[132:135], v[64:67]
    v_mfma_f32_16x16x32_bf16 v[8:11], v[108:111], v[120:123], v[8:11]
    v_mfma_f32_16x16x32_bf16 v[28:31], v[108:111], v[124:127], v[28:31]
    v_mfma_f32_16x16x32_bf16 v[48:51], v[108:111], v[128:131], v[48:51]
    v_mfma_f32_16x16x32_bf16 v[68:71], v[108:111], v[132:135], v[68:71]
    v_mfma_f32_16x16x32_bf16 v[12:15], v[112:115], v[120:123], v[12:15]
    v_mfma_f32_16x16x32_bf16 v[32:35], v[112:115], v[124:127], v[32:35]
    v_mfma_f32_16x16x32_bf16 v[52:55], v[112:115], v[128:131], v[52:55]
    v_mfma_f32_16x16x32_bf16 v[72:75], v[112:115], v[132:135], v[72:75]
    v_mfma_f32_16x16x32_bf16 v[16:19], v[116:119], v[120:123], v[16:19]
    v_mfma_f32_16x16x32_bf16 v[36:39], v[116:119], v[124:127], v[36:39]
    v_mfma_f32_16x16x32_bf16 v[56:59], v[116:119], v[128:131], v[56:59]
    v_mfma_f32_16x16x32_bf16 v[76:79], v[116:119], v[132:135], v[76:79]
    s_mov_b32 s53, 0
    s_waitcnt vmcnt(20)
    v_max3_u32 v224, v136, v137, v138
    v_max3_u32 v225, v139, v140, v141
    v_max3_u32 v224, v224, v142, v143
    v_max3_u32 v225, v225, v144, v145
    v_max3_u32 v224, v224, v146, v147
    v_max3_u32 v225, v225, v148, v149
    v_max3_u32 v224, v224, v150, v151
    v_max_u32 v224, v224, v225
    v_cmp_eq_u32 vcc, -1, v224
    s_nop 1
    s_cbranch_vccnz L_oretry0
L_ook0:
    s_waitcnt lgkmcnt(0)
    v_mfma_f32_16x16x32_bf16 v[0:3], v[80:83], v[136:139], v[0:3]
    ds_read_b64_tr_b16 v[100:101], v239 offset:6400
    v_mfma_f32_16x16x32_bf16 v[4:7], v[84:87], v[136:139], v[4:7]
    ds_read_b64_tr_b16 v[102:103], v239 offset:7680
    v_mfma_f32_16x16x32_bf16 v[8:11], v[88:91], v[136:139], v[8:11]
    ds_read_b64_tr_b16 v[104:105], v239 offset:6432
    v_mfma_f32_16x16x32_bf16 v[12:15], v[92:95], v[136:139], v[12:15]
    ds_read_b64_tr_b16 v[106:107], v239 offset:7712
    v_mfma_f32_16x16x32_bf16 v[16:19], v[96:99], v[136:139], v[16:19]
    ds_read_b64_tr_b16 v[108:109], v239 offset:6464
    v_mfma_f32_16x16x32_bf16 v[20:23], v[80:83], v[140:143], v[20:23]
    ds_read_b64_tr_b16 v[110:111], v239 offset:7744
    v_mfma_f32_16x16x32_bf16 v[24:27], v[84:87], v[140:143], v[24:27]
    ds_read_b64_tr_b16 v[112:113], v239 offset:6496
    v_mfma_f32_16x16x32_bf16 v[28:31], v[88:91], v[140:143], v[28:31]
    ds_read_b64_tr_b16 v[114:115], v239 offset:7776
    v_mfma_f32_16x16x32_bf16 v[32:35], v[92:95], v[140:143], v[32:35]
    ds_read_b64_tr_b16 v[116:117], v239 offset:6528
    s_waitcnt vmcnt(16)
    v_mfma_f32_16x16x32_bf16 v[36:39], v[96:99], v[140:143], v[36:39]
    ds_read_b64_tr_b16 v[118:119], v239 offset:7808
    v_max3_u32 v224, v152, v153, v154
    v_mfma_f32_16x16x32_bf16 v[40:43], v[80:83], v[144:147], v[40:43]
    v_max3_u32 v225, v155, v156, v157
    v_mfma_f32_16x16x32_bf16 v[44:47], v[84:87], v[144:147], v[44:47]
    v_max3_u32 v224, v224, v158, v159
    v_mfma_f32_16x16x32_bf16 v[48:51], v[88:91], v[144:147], v[48:51]
    v_max3_u32 v225, v225, v160, v161
    v_mfma_f32_16x16x32_bf16 v[52:55], v[92:95], v[144:147], v[52:55]
    v_max3_u32 v224, v224, v162, v163
    v_mfma_f32_16x16x32_bf16 v[56:59], v[96:99], v[144:147], v[56:59]
    v_max3_u32 v225, v225, v164, v165
    v_mfma_f32_16x16x32_bf16 v[60:63], v[80:83], v[148:151], v[60:63]
    v_max3_u32 v224, v224, v166, v167
    v_mfma_f32_16x16x32_bf16 v[64:67], v[84:87], v[148:151], v[64:67]
    v_max_u32 v224, v224, v225
    v_mfma_f32_16x16x32_bf16 v[68:71], v[88:91], v[148:151], v[68:71]
    v_cmp_eq_u32 vcc, -1, v224
    v_mfma_f32_16x16x32_bf16 v[72:75], v[92:95], v[148:151], v[72:75]
    v_mfma_f32_16x16x32_bf16 v[76:79], v[96:99], v[148:151], v[76:79]
    s_cbranch_vccnz L_oretry1
L_ook1:
    s_waitcnt lgkmcnt(0)
    v_mfma_f32_16x16x32_bf16 v[0:3], v[100:103], v[152:155], v[0:3]
    ds_read_b64_tr_b16 v[80:81], v239 offset:12800
    v_mfma_f32_16x16x32_bf16 v[4:7], v[104:107], v[152:155], v[4:7]
    ds_read_b64_tr_b16 v[82:83], v239 offset:14080
    v_mfma_f32_16x16x32_bf16 v[8:11], v[108:111], v[152:155], v[8:11]
    ds_read_b64_tr_b16 v[84:85], v239 offset:12832
    v_mfma_f32_16x16x32_bf16 v[12:15], v[112:115], v[152:155], v[12:15]
    ds_read_b64_tr_b16 v[86:87], v239 offset:14112
    v_mfma_f32_16x16x32_bf16 v[16:19], v[116:119], v[152:155], v[16:19]
    ds_read_b64_tr_b16 v[88:89], v239 offset:12864
    v_mfma_f32_16x16x32_bf16 v[20:23], v[100:103], v[156:159], v[20:23]
    ds_read_b64_tr_b16 v[90:91], v239 offset:14144
    v_mfma_f32_16x16x32_bf16 v[24:27], v[104:107], v[156:159], v[24:27]
    ds_read_b64_tr_b16 v[92:93], v239 offset:12896
    v_mfma_f32_16x16x32_bf16 v[28:31], v[108:111], v[156:159], v[28:31]
    ds_read_b64_tr_b16 v[94:95], v239 offset:14176
    v_mfma_f32_16x16x32_bf16 v[32:35], v[112:115], v[156:159], v[32:35]
    ds_read_b64_tr_b16 v[96:97], v239 offset:12928
    s_waitcnt vmcnt(12)
    v_mfma_f32_16x16x32_bf16 v[36:39], v[116:119], v[156:159], v[36:39]
    ds_read_b64_tr_b16 v[98:99], v239 offset:14208
    v_max3_u32 v224, v168, v169, v170
    v_mfma_f32_16x16x32_bf16 v[40:43], v[100:103], v[160:163], v[40:43]
    v_max3_u32 v225, v171, v172, v173
    v_mfma_f32_16x16x32_bf16 v[44:47], v[104:107], v[160:163], v[44:47]
    v_max3_u32 v224, v224, v174, v175
    v_mfma_f32_16x16x32_bf16 v[48:51], v[108:111], v[160:163], v[48:51]
    v_max3_u32 v225, v225, v176, v177
    v_mfma_f32_16x16x32_bf16 v[52:55], v[112:115], v[160:163], v[52:55]
    v_max3_u32 v224, v224, v178, v179
    v_mfma_f32_16x16x32_bf16 v[56:59], v[116:119], v[160:163], v[56:59]
    v_max3_u32 v225, v225, v180, v181
    v_mfma_f32_16x16x32_bf16 v[60:63], v[100:103], v[164:167], v[60:63]
    v_max3_u32 v224, v224, v182, v183
    v_mfma_f32_16x16x32_bf16 v[64:67], v[104:107], v[164:167], v[64:67]
    v_max_u32 v224, v224, v225
    v_mfma_f32_16x16x32_bf16 v[68:71], v[108:111], v[164:167], v[68:71]
    v_cmp_eq_u32 vcc, -1, v224
    v_mfma_f32_16x16x32_bf16 v[72:75], v[112:115], v[164:167], v[72:75]
    v_mfma_f32_16x16x32_bf16 v[76:79], v[116:119], v[164:167], v[76:79]
    s_cbranch_vccnz L_oretry2
L_ook2:
    s_waitcnt lgkmcnt(0)
    v_mfma_f32_16x16x32_bf16 v[0:3], v[80:83], v[168:171], v[0:3]
    ds_read_b64_tr_b16 v[100:101], v239 offset:19200
    v_mfma_f32_16x16x32_bf16 v[4:7], v[84:87], v[168:171], v[4:7]
    ds_read_b64_tr_b16 v[102:103], v239 offset:20480
    v_mfma_f32_16x16x32_bf16 v[8:11], v[88:91], v[168:171], v[8:11]
    ds_read_b64_tr_b16 v[104:105], v239 offset:19232
    v_mfma_f32_16x16x32_bf16 v[12:15], v[92:95], v[168:171], v[12:15]
    ds_read_b64_tr_b16 v[106:107], v239 offset:20512
    v_mfma_f32_16x16x32_bf16 v[16:19], v[96:99], v[168:171], v[16:19]
    ds_read_b64_tr_b16 v[108:109], v239 offset:19264
    v_mfma_f32_16x16x32_bf16 v[20:23], v[80:83], v[172:175], v[20:23]
    ds_read_b64_tr_b16 v[110:111], v239 offset:20544
    v_mfma_f32_16x16x32_bf16 v[24:27], v[84:87], v[172:175], v[24:27]
    ds_read_b64_tr_b16 v[112:113], v239 offset:19296
    v_mfma_f32_16x16x32_bf16 v[28:31], v[88:91], v[172:175], v[28:31]
    ds_read_b64_tr_b16 v[114:115], v239 offset:20576
    v_mfma_f32_16x16x32_bf16 v[32:35], v[92:95], v[172:175], v[32:35]
    ds_read_b64_tr_b16 v[116:117], v239 offset:19328
    s_waitcnt vmcnt(8)
    v_mfma_f32_16x16x32_bf16 v[36:39], v[96:99], v[172:175], v[36:39]
    ds_read_b64_tr_b16 v[118:119], v239 offset:20608
    v_max3_u32 v224, v184, v185, v186
    v_mfma_f32_16x16x32_bf16 v[40:43], v[80:83], v[176:179], v[40:43]
    v_max3_u32 v225, v187, v188, v189
    v_mfma_f32_16x16x32_bf16 v[44:47], v[84:87], v[176:179], v[44:47]
    v_max3_u32 v224, v224, v190, v191
    v_mfma_f32_16x16x32_bf16 v[48:51], v[88:91], v[176:179], v[48:51]
    v_max3_u32 v225, v225, v192, v193
    v_mfma_f32_16x16x32_bf16 v[52:55], v[92:95], v[176:179], v[52:55]
    v_max3_u32 v224, v224, v194, v195
    v_mfma_f32_16x16x32_bf16 v[56:59], v[96:99], v[176:179], v[56:59]
    v_max3_u32 v225, v225, v196, v197
    v_mfma_f32_16x16x32_bf16 v[60:63], v[80:83], v[180:183], v[60:63]
    v_max3_u32 v224, v224, v198, v199
    v_mfma_f32_16x16x32_bf16 v[64:67], v[84:87], v[180:183], v[64:67]
    v_max_u32 v224, v224, v225
    v_mfma_f32_16x16x32_bf16 v[68:71], v[88:91], v[180:183], v[68:71]
    v_cmp_eq_u32 vcc, -1, v224
    v_mfma_f32_16x16x32_bf16 v[72:75], v[92:95], v[180:183], v[72:75]
    v_mfma_f32_16x16x32_bf16 v[76:79], v[96:99], v[180:183], v[76:79]
    s_cbranch_vccnz L_oretry3
L_ook3:
    s_waitcnt lgkmcnt(0)
    v_mfma_f32_16x16x32_bf16 v[0:3], v[100:103], v[184:187], v[0:3]
    ds_read_b64_tr_b16 v[80:81], v240 offset:0
    v_mfma_f32_16x16x32_bf16 v[4:7], v[104:107], v[184:187], v[4:7]
    ds_read_b64_tr_b16 v[82:83], v240 offset:3200
    v_mfma_f32_16x16x32_bf16 v[8:11], v[108:111], v[184:187], v[8:11]
    ds_read_b64_tr_b16 v[84:85], v240 offset:32
    v_mfma_f32_16x16x32_bf16 v[12:15], v[112:115], v[184:187], v[12:15]
    ds_read_b64_tr_b16 v[86:87], v240 offset:3232
    v_mfma_f32_16x16x32_bf16 v[16:19], v[116:119], v[184:187], v[16:19]
    ds_read_b64_tr_b16 v[88:89], v240 offset:64
    v_mfma_f32_16x16x32_bf16 v[20:23], v[100:103], v[188:191], v[20:23]
    ds_read_b64_tr_b16 v[90:91], v240 offset:3264
    v_mfma_f32_16x16x32_bf16 v[24:27], v[104:107], v[188:191], v[24:27]
    ds_read_b64_tr_b16 v[92:93], v240 offset:96
    v_mfma_f32_16x16x32_bf16 v[28:31], v[108:111], v[188:191], v[28:31]
    ds_read_b64_tr_b16 v[94:95], v240 offset:3296
    v_mfma_f32_16x16x32_bf16 v[32:35], v[112:115], v[188:191], v[32:35]
    ds_read_b64_tr_b16 v[96:97], v240 offset:128
    s_waitcnt vmcnt(0)
    v_mfma_f32_16x16x32_bf16 v[36:39], v[116:119], v[188:191], v[36:39]
    ds_read_b64_tr_b16 v[98:99], v240 offset:3328
    v_max3_u32 v224, v200, v201, v202
    v_mfma_f32_16x16x32_bf16 v[40:43], v[100:103], v[192:195], v[40:43]
    v_max3_u32 v225, v203, v204, v205
    v_mfma_f32_16x16x32_bf16 v[44:47], v[104:107], v[192:195], v[44:47]
    v_max3_u32 v224, v224, v206, v207
    v_mfma_f32_16x16x32_bf16 v[48:51], v[108:111], v[192:195], v[48:51]
    v_max3_u32 v225, v225, v208, v209
    v_mfma_f32_16x16x32_bf16 v[52:55], v[112:115], v[192:195], v[52:55]
    v_max3_u32 v224, v224, v210, v211
    v_mfma_f32_16x16x32_bf16 v[56:59], v[116:119], v[192:195], v[56:59]
    v_max3_u32 v225, v225, v212, v213
    v_mfma_f32_16x16x32_bf16 v[60:63], v[100:103], v[196:199], v[60:63]
    v_max3_u32 v224, v224, v214, v215
    v_mfma_f32_16x16x32_bf16 v[64:67], v[104:107], v[196:199], v[64:67]
    v_max_u32 v224, v224, v225
    v_mfma_f32_16x16x32_bf16 v[68:71], v[108:111], v[196:199], v[68:71]
    v_cmp_eq_u32 vcc, -1, v224
    v_mfma_f32_16x16x32_bf16 v[72:75], v[112:115], v[196:199], v[72:75]
    v_mfma_f32_16x16x32_bf16 v[76:79], v[116:119], v[196:199], v[76:79]
    s_cbranch_vccnz L_oretry4
L_ook4:
    s_waitcnt lgkmcnt(0)
    v_mfma_f32_16x16x32_bf16 v[0:3], v[80:83], v[200:203], v[0:3]
    v_mfma_f32_16x16x32_bf16 v[4:7], v[84:87], v[200:203], v[4:7]
    v_mfma_f32_16x16x32_bf16 v[8:11], v[88:91], v[200:203], v[8:11]
    v_mfma_f32_16x16x32_bf16 v[12:15], v[92:95], v[200:203], v[12:15]
    v_mfma_f32_16x16x32_bf16 v[16:19], v[96:99], v[200:203], v[16:19]
    v_mfma_f32_16x16x32_bf16 v[20:23], v[80:83], v[204:207], v[20:23]
    v_mfma_f32_16x16x32_bf16 v[24:27], v[84:87], v[204:207], v[24:27]
    v_mfma_f32_16x16x32_bf16 v[28:31], v[88:91], v[204:207], v[28:31]
    v_mfma_f32_16x16x32_bf16 v[32:35], v[92:95], v[204:207], v[32:35]
    v_mfma_f32_16x16x32_bf16 v[36:39], v[96:99], v[204:207], v[36:39]
    ds_write_b128 v243, v[0:3] offset:0
    v_mfma_f32_16x16x32_bf16 v[40:43], v[80:83], v[208:211], v[40:43]
    ds_write_b128 v243, v[4:7] offset:64
    v_mfma_f32_16x16x32_bf16 v[44:47], v[84:87], v[208:211], v[44:47]
    ds_write_b128 v243, v[8:11] offset:128
    v_mfma_f32_16x16x32_bf16 v[48:51], v[88:91], v[208:211], v[48:51]
    ds_write_b128 v243, v[12:15] offset:192
    v_mfma_f32_16x16x32_bf16 v[52:55], v[92:95], v[208:211], v[52:55]
    ds_write_b128 v243, v[16:19] offset:256
    v_mfma_f32_16x16x32_bf16 v[56:59], v[96:99], v[208:211], v[56:59]
    ds_write_b128 v243, v[20:23] offset:5376
    v_mfma_f32_16x16x32_bf16 v[60:63], v[80:83], v[212:215], v[60:63]
    ds_write_b128 v243, v[24:27] offset:5440
    v_mfma_f32_16x16x32_bf16 v[64:67], v[84:87], v[212:215], v[64:67]
    ds_write_b128 v243, v[28:31] offset:5504
    v_mfma_f32_16x16x32_bf16 v[68:71], v[88:91], v[212:215], v[68:71]
    ds_write_b128 v243, v[32:35] offset:5568
    v_mfma_f32_16x16x32_bf16 v[72:75], v[92:95], v[212:215], v[72:75]
    ds_write_b128 v243, v[36:39] offset:5632
    v_mfma_f32_16x16x32_bf16 v[76:79], v[96:99], v[212:215], v[76:79]
    ds_write_b128 v243, v[40:43] offset:10752
    ds_write_b128 v243, v[44:47] offset:10816
    ds_write_b128 v243, v[48:51] offset:10880
    ds_write_b128 v243, v[52:55] offset:10944
    ds_write_b128 v243, v[56:59] offset:11008
    ds_write_b128 v243, v[60:63] offset:16128
    ds_write_b128 v243, v[64:67] offset:16192
    ds_write_b128 v243, v[68:71] offset:16256
    ds_write_b128 v243, v[72:75] offset:16320
    ds_write_b128 v243, v[76:79] offset:16384
    v_lshlrev_b32 v80, 16, v234
    v_and_b32 v81, 0xffff0000, v234
    v_lshlrev_b32 v82, 16, v235
    v_and_b32 v83, 0xffff0000, v235
    v_add_u32 v90, 55296, v247
    v_lshlrev_b32 v84, 16, v236
    v_and_b32 v85, 0xffff0000, v236
    v_lshlrev_b32 v86, 16, v237
    v_and_b32 v87, 0xffff0000, v237
    v_add_u32 v91, 55296, v251
    s_waitcnt lgkmcnt(0)
    s_barrier
    ds_read_b128 v[0:3], v247
    ds_read_b128 v[4:7], v247 offset:27648
    ds_read_b128 v[8:11], v90
    ds_read_b128 v[12:15], v90 offset:27648
    ds_read_b128 v[16:19], v251
    ds_read_b128 v[20:23], v251 offset:27648
    ds_read_b128 v[24:27], v91
    ds_read_b128 v[28:31], v91 offset:27648
    s_waitcnt lgkmcnt(4)
    v_pk_add_f32 v[0:1], v[0:1], v[4:5]
    v_pk_add_f32 v[2:3], v[2:3], v[6:7]
    v_pk_add_f32 v[8:9], v[8:9], v[12:13]
    v_pk_add_f32 v[10:11], v[10:11], v[14:15]
    v_pk_add_f32 v[0:1], v[0:1], v[80:81]
    v_pk_add_f32 v[2:3], v[2:3], v[82:83]
    v_pk_add_f32 v[0:1], v[0:1], v[8:9]
    v_pk_add_f32 v[2:3], v[2:3], v[10:11]
    v_cvt_pk_bf16_f32 v4, v0, v1
    v_cvt_pk_bf16_f32 v5, v2, v3
    buffer_store_dwordx2 v[4:5], v245, s[12:15], s55 offen
    s_waitcnt lgkmcnt(0)
    v_pk_add_f32 v[16:17], v[16:17], v[20:21]
    v_pk_add_f32 v[18:19], v[18:19], v[22:23]
    v_pk_add_f32 v[24:25], v[24:25], v[28:29]
    v_pk_add_f32 v[26:27], v[26:27], v[30:31]
    v_pk_add_f32 v[16:17], v[16:17], v[84:85]
    v_pk_add_f32 v[18:19], v[18:19], v[86:87]
    v_pk_add_f32 v[16:17], v[16:17], v[24:25]
    v_pk_add_f32 v[18:19], v[18:19], v[26:27]
    v_cvt_pk_bf16_f32 v20, v16, v17
    v_cvt_pk_bf16_f32 v21, v18, v19
    buffer_store_dwordx2 v[20:21], v246, s[12:15], s55 offen
    s_branch L_fin
L_oretry0:
    s_add_u32 s53, s53, 1
    s_cmp_gt_u32 s53, 32768
    s_cbranch_scc1 L_ook0
    s_waitcnt vmcnt(0)
    s_add_u32 s3, s48, 0
    buffer_load_dwordx4 v[136:139], v241, s[16:19], s3 offen offset:0 sc1
    buffer_load_dwordx4 v[140:143], v241, s[16:19], s3 offen offset:256 sc1
    s_add_u32 s3, s48, 41216
    buffer_load_dwordx4 v[144:147], v241, s[16:19], s3 offen offset:0 sc1
    buffer_load_dwordx4 v[148:151], v241, s[16:19], s3 offen offset:256 sc1
    s_waitcnt vmcnt(0)
    s_waitcnt vmcnt(20)
    v_max3_u32 v224, v136, v137, v138
    v_max3_u32 v225, v139, v140, v141
    v_max3_u32 v224, v224, v142, v143
    v_max3_u32 v225, v225, v144, v145
    v_max3_u32 v224, v224, v146, v147
    v_max3_u32 v225, v225, v148, v149
    v_max3_u32 v224, v224, v150, v151
    v_max_u32 v224, v224, v225
    v_cmp_eq_u32 vcc, -1, v224
    s_nop 1
    s_cbranch_vccnz L_oretry0
    s_branch L_ook0
L_oretry1:
    s_add_u32 s53, s53, 1
    s_cmp_gt_u32 s53, 32768
    s_cbranch_scc1 L_ook1
    s_waitcnt vmcnt(0)
    s_add_u32 s3, s48, 2560
    buffer_load_dwordx4 v[152:155], v241, s[16:19], s3 offen offset:0 sc1
    buffer_load_dwordx4 v[156:159], v241, s[16:19], s3 offen offset:256 sc1
    s_add_u32 s3, s48, 43776
    buffer_load_dwordx4 v[160:163], v241, s[16:19], s3 offen offset:0 sc1
    buffer_load_dwordx4 v[164:167], v241, s[16:19], s3 offen offset:256 sc1
    s_waitcnt vmcnt(0)
    s_waitcnt vmcnt(16)
    v_max3_u32 v224, v152, v153, v154
    v_max3_u32 v225, v155, v156, v157
    v_max3_u32 v224, v224, v158, v159
    v_max3_u32 v225, v225, v160, v161
    v_max3_u32 v224, v224, v162, v163
    v_max3_u32 v225, v225, v164, v165
    v_max3_u32 v224, v224, v166, v167
    v_max_u32 v224, v224, v225
    v_cmp_eq_u32 vcc, -1, v224
    s_nop 1
    s_cbranch_vccnz L_oretry1
    s_branch L_ook1
L_oretry2:
    s_add_u32 s53, s53, 1
    s_cmp_gt_u32 s53, 32768
    s_cbranch_scc1 L_ook2
    s_waitcnt vmcnt(0)
    s_add_u32 s3, s48, 5120
    buffer_load_dwordx4 v[168:171], v241, s[16:19], s3 offen offset:0 sc1
    buffer_load_dwordx4 v[172:175], v241, s[16:19], s3 offen offset:256 sc1
    s_add_u32 s3, s48, 46336
    buffer_load_dwordx4 v[176:179], v241, s[16:19], s3 offen offset:0 sc1
    buffer_load_dwordx4 v[180:183], v241, s[16:19], s3 offen offset:256 sc1
    s_waitcnt vmcnt(0)
    s_waitcnt vmcnt(12)
    v_max3_u32 v224, v168, v169, v170
    v_max3_u32 v225, v171, v172, v173
    v_max3_u32 v224, v224, v174, v175
    v_max3_u32 v225, v225, v176, v177
    v_max3_u32 v224, v224, v178, v179
    v_max3_u32 v225, v225, v180, v181
    v_max3_u32 v224, v224, v182, v183
    v_max_u32 v224, v224, v225
    v_cmp_eq_u32 vcc, -1, v224
    s_nop 1
    s_cbranch_vccnz L_oretry2
    s_branch L_ook2
L_oretry3:
    s_add_u32 s53, s53, 1
    s_cmp_gt_u32 s53, 32768
    s_cbranch_scc1 L_ook3
    s_waitcnt vmcnt(0)
    s_add_u32 s3, s48, 7680
    buffer_load_dwordx4 v[184:187], v241, s[16:19], s3 offen offset:0 sc1
    buffer_load_dwordx4 v[188:191], v241, s[16:19], s3 offen offset:256 sc1
    s_add_u32 s3, s48, 48896
    buffer_load_dwordx4 v[192:195], v241, s[16:19], s3 offen offset:0 sc1
    buffer_load_dwordx4 v[196:199], v241, s[16:19], s3 offen offset:256 sc1
    s_waitcnt vmcnt(0)
    s_waitcnt vmcnt(8)
    v_max3_u32 v224, v184, v185, v186
    v_max3_u32 v225, v187, v188, v189
    v_max3_u32 v224, v224, v190, v191
    v_max3_u32 v225, v225, v192, v193
    v_max3_u32 v224, v224, v194, v195
    v_max3_u32 v225, v225, v196, v197
    v_max3_u32 v224, v224, v198, v199
    v_max_u32 v224, v224, v225
    v_cmp_eq_u32 vcc, -1, v224
    s_nop 1
    s_cbranch_vccnz L_oretry3
    s_branch L_ook3
L_oretry4:
    s_add_u32 s53, s53, 1
    s_cmp_gt_u32 s53, 32768
    s_cbranch_scc1 L_ook4
    s_waitcnt vmcnt(0)
    s_add_u32 s3, s48, 1024
    buffer_load_dwordx2 v[200:201], v242, s[16:19], s3 offen offset:0 sc1
    buffer_load_dwordx2 v[202:203], v242, s[16:19], s3 offen offset:1280 sc1
    buffer_load_dwordx2 v[204:205], v242, s[16:19], s3 offen offset:128 sc1
    buffer_load_dwordx2 v[206:207], v242, s[16:19], s3 offen offset:1408 sc1
    s_add_u32 s3, s48, 42240
    buffer_load_dwordx2 v[208:209], v242, s[16:19], s3 offen offset:0 sc1
    buffer_load_dwordx2 v[210:211], v242, s[16:19], s3 offen offset:1280 sc1
    buffer_load_dwordx2 v[212:213], v242, s[16:19], s3 offen offset:128 sc1
    buffer_load_dwordx2 v[214:215], v242, s[16:19], s3 offen offset:1408 sc1
    s_waitcnt vmcnt(0)
    s_waitcnt vmcnt(0)
    v_max3_u32 v224, v200, v201, v202
    v_max3_u32 v225, v203, v204, v205
    v_max3_u32 v224, v224, v206, v207
    v_max3_u32 v225, v225, v208, v209
    v_max3_u32 v224, v224, v210, v211
    v_max3_u32 v225, v225, v212, v213
    v_max3_u32 v224, v224, v214, v215
    v_max_u32 v224, v224, v225
    v_cmp_eq_u32 vcc, -1, v224
    s_nop 1
    s_cbranch_vccnz L_oretry4
    s_branch L_ook4
L_h_first:
    s_waitcnt vmcnt(0)
    buffer_load_dword v93, v94, s[24:27], 0 offen sc1
    s_waitcnt vmcnt(1)
    s_barrier
    s_setprio 2
    s_waitcnt vmcnt(0)
    v_cmp_gt_u32 vcc, 6, v93
    s_nop 4
    s_cbranch_vccnz L_h_late
    s_lshl_b32 s38, s33, 11
    s_lshl_b32 s39, s34, 9
    s_add_u32 s39, s39, 16384
    buffer_load_dwordx2 v[100:101], v95, s[20:23], s38 offen offset:0 sc1
    buffer_load_dwordx2 v[102:103], v95, s[20:23], s38 offen offset:512 sc1
    buffer_load_dwordx2 v[104:105], v95, s[20:23], s38 offen offset:1024 sc1
    buffer_load_dwordx2 v[106:107], v95, s[20:23], s38 offen offset:1536 sc1
    buffer_load_dword v108, v98, s[20:23], s39 offen offset:0 sc1
    buffer_load_dword v109, v98, s[20:23], s39 offen offset:256 sc1
    s_add_u32 s39, s39, 14848
    buffer_load_dword v110, v98, s[20:23], s39 offen offset:0 sc1
    buffer_load_dword v111, v98, s[20:23], s39 offen offset:256 sc1
    s_add_u32 s39, s39, 14848
    buffer_load_dword v112, v98, s[20:23], s39 offen offset:0 sc1
    buffer_load_dword v113, v98, s[20:23], s39 offen offset:256 sc1
    s_barrier
    s_cmp_eq_u32 s35, 0
    s_cselect_b32 s3, 1051011932, 1.0
    s_cmp_eq_u32 s35, 2
    s_movk_i32 s38, 512
    s_cselect_b32 s38, 256, s38
    v_mov_b32 v90, v97
    v_mov_b32 v91, v96
    s_waitcnt vmcnt(0)
    v_add_f32 v108, v108, v110
    v_add_f32 v109, v109, v111
    v_mul_f32 v100, s3, v100
    v_mul_f32 v102, s3, v102
    v_mul_f32 v104, s3, v104
    v_mul_f32 v106, s3, v106
    v_add_f32 v108, v108, v112
    v_add_f32 v109, v109, v113
    ds_write_b32 v90, v100
    ds_write_b32 v91, v101
    v_add_u32 v90, s38, v90
    v_add_u32 v91, s38, v91
    ds_write_b32 v90, v102
    ds_write_b32 v91, v103
    v_add_u32 v90, s38, v90
    v_add_u32 v91, s38, v91
    ds_write_b32 v90, v104
    ds_write_b32 v91, v105
    v_add_u32 v90, s38, v90
    v_add_u32 v91, s38, v91
    ds_write_b32 v90, v106
    ds_write_b32 v91, v107
    ds_write2st64_b32 v92, v108, v109 offset0:0 offset1:1
    s_waitcnt lgkmcnt(0)
    s_branch L_h_join
L_h_late:
    buffer_load_dword v93, v94, s[24:27], 0 offen sc1
    s_barrier
    s_waitcnt vmcnt(0)
    v_cmp_gt_u32 vcc, 6, v93
    s_nop 4
    s_cbranch_vccz L_h_late2
    s_mov_b32 exec_lo, 15
    s_mov_b32 exec_hi, 0
    s_mov_b32 s53, 0
L_poll_p0_11:
    buffer_load_dword v93, v94, s[24:27], 0 offen sc1
    s_add_u32 s53, s53, 1
    s_waitcnt vmcnt(0)
    v_cmp_gt_u32 vcc, 6, v93
    s_cmp_gt_u32 s53, 32768
    s_cbranch_scc1 L_polled_p0_12
    s_cbranch_vccz L_polled_p0_12
    s_sleep 8
    s_branch L_poll_p0_11
L_polled_p0_12:
    s_mov_b64 exec, -1
L_h_late2:
    s_lshl_b32 s38, s33, 11
    s_lshl_b32 s39, s34, 9
    s_add_u32 s39, s39, 16384
    buffer_load_dwordx2 v[100:101], v95, s[20:23], s38 offen offset:0 sc1
    buffer_load_dwordx2 v[102:103], v95, s[20:23], s38 offen offset:512 sc1
    buffer_load_dwordx2 v[104:105], v95, s[20:23], s38 offen offset:1024 sc1
    buffer_load_dwordx2 v[106:107], v95, s[20:23], s38 offen offset:1536 sc1
    buffer_load_dword v108, v98, s[20:23], s39 offen offset:0 sc1
    buffer_load_dword v109, v98, s[20:23], s39 offen offset:256 sc1
    s_add_u32 s39, s39, 14848
    buffer_load_dword v110, v98, s[20:23], s39 offen offset:0 sc1
    buffer_load_dword v111, v98, s[20:23], s39 offen offset:256 sc1
    s_add_u32 s39, s39, 14848
    buffer_load_dword v112, v98, s[20:23], s39 offen offset:0 sc1
    buffer_load_dword v113, v98, s[20:23], s39 offen offset:256 sc1
    s_cmp_eq_u32 s35, 0
    s_cselect_b32 s3, 1051011932, 1.0
    s_cmp_eq_u32 s35, 2
    s_movk_i32 s38, 512
    s_cselect_b32 s38, 256, s38
    v_mov_b32 v90, v97
    v_mov_b32 v91, v96
    s_waitcnt vmcnt(0)
    v_add_f32 v108, v108, v110
    v_add_f32 v109, v109, v111
    v_mul_f32 v100, s3, v100
    v_mul_f32 v102, s3, v102
    v_mul_f32 v104, s3, v104
    v_mul_f32 v106, s3, v106
    v_add_f32 v108, v108, v112
    v_add_f32 v109, v109, v113
    ds_write_b32 v90, v100
    ds_write_b32 v91, v101
    v_add_u32 v90, s38, v90
    v_add_u32 v91, s38, v91
    ds_write_b32 v90, v102
    ds_write_b32 v91, v103
    v_add_u32 v90, s38, v90
    v_add_u32 v91, s38, v91
    ds_write_b32 v90, v104
    ds_write_b32 v91, v105
    v_add_u32 v90, s38, v90
    v_add_u32 v91, s38, v91
    ds_write_b32 v90, v106
    ds_write_b32 v91, v107
    ds_write2st64_b32 v92, v108, v109 offset0:0 offset1:1
    s_waitcnt lgkmcnt(0)
L_h_join:
    s_barrier
    s_setprio 0
    s_branch L_b_phase2b
L_compute:
    s_mul_i32 s44, s36, 29
    s_add_u32 s44, s44, s37
    s_sub_u32 s44, s44, 3
    s_cmp_eq_u32 s32, 1
    s_cselect_b64 s[16:17], s[6:7], s[56:57]
    s_mov_b32 s18, 2211840
    s_cselect_b32 s18, 2457600, s18
    s_cselect_b32 s45, 58, 53
    s_mov_b32 s46, 5184
    s_cselect_b32 s46, 5760, s46
    s_mul_i32 s47, s44, s45
    s_add_u32 s46, s46, s47
    s_sub_u32 s45, s45, 1
    v_min_u32 v2, s45, v255
    v_add_lshl_u32 v250, v2, s46, 7
    v_min_u32 v2, 62, v255
    v_mul_u32_u24 v3, 586, v2
    v_lshrrev_b32 v3, 12, v3
    v_mul_u32_u24 v4, 384, v3
    v_lshl_add_u32 v2, v2, 7, v4
    s_mul_i32 s44, s44, 11520
    s_add_u32 s44, s44, 384
    v_add_u32 v2, s44, v2
    s_cmp_eq_u32 s32, 0
    s_cselect_b64 vcc, -1, 0
    s_cselect_b64 s[16:17], s[4:5], s[16:17]
    s_cselect_b32 s18, 2621440, s18
    s_cmp_eq_u32 s32, 3
    s_cselect_b32 s18, 0, s18
    v_cndmask_b32 v250, v250, v2, vcc
    buffer_load_dword v252, v250, s[16:19], 0 offen
    s_and_b32 s44, s32, 1
    s_lshr_b32 s45, s32, 1
    v_and_b32 v2, 15, v255
    v_lshrrev_b32 v3, 4, v255
    s_lshl_b32 s38, s44, 14
    v_lshrrev_b32 v4, 1, v2
    v_xor_b32 v4, v4, v3
    v_lshl_add_u32 v5, v2, 7, s38
    v_lshl_add_u32 v230, v4, 4, v5
    v_xor_b32 v4, 4, v4
    v_lshl_add_u32 v231, v4, 4, v5
    v_lshrrev_b32 v4, 2, v2
    v_lshl_add_u32 v5, v3, 3, v4
    v_lshlrev_b32 v5, 8, v5
    v_and_b32 v6, 1, v2
    v_lshl_add_u32 v5, v6, 3, v5
    v_and_b32 v6, 1, v3
    v_lshlrev_b32 v6, 3, v6
    v_lshl_add_u32 v6, v4, 1, v6
    v_bfe_u32 v7, v2, 1, 1
    v_lshl_add_u32 v7, s45, 3, v7
    v_xor_b32 v6, v6, v7
    v_xor_b32 v7, 0, v6
    v_lshl_add_u32 v232, v7, 4, v5
    v_xor_b32 v7, 2, v6
    v_lshl_add_u32 v233, v7, 4, v5
    v_xor_b32 v7, 4, v6
    v_lshl_add_u32 v234, v7, 4, v5
    v_xor_b32 v7, 6, v6
    v_lshl_add_u32 v235, v7, 4, v5
    v_mov_b32 v224, v230
    v_mov_b32 v225, v231
    v_mov_b32 v226, v232
    v_mov_b32 v227, v233
    v_mov_b32 v228, v234
    v_mov_b32 v229, v235
    s_lshl_b32 s55, s33, 3
    s_lshl_b32 s38, s44, 2
    s_add_u32 s55, s55, s38
    s_mul_i32 s38, s35, 5
    s_sub_u32 s38, s34, s38
    s_lshl_b32 s38, s38, 1
    s_add_u32 s38, s38, s45
    s_lshl_b32 s50, s38, 4
    s_cmp_eq_u32 s35, 3
    s_mov_b32 s46, 164096
    s_movk_i32 s54, 2560
    s_mov_b32 s47, 2629632
    s_mov_b32 s10, 5251072
    s_cselect_b32 s46, 1280, s46
    s_cselect_b32 s54, 110848, s54
    s_cselect_b32 s47, 7880704, s47
    s_cselect_b32 s10, 7094272, s10
    s_cmp_eq_u32 s35, 0
    s_cselect_b32 s46, 82176, s46
    s_cselect_b32 s54, 1280, s54
    s_cselect_b32 s47, 0, s47
    s_cselect_b32 s10, 2629632, s10
    s_cmp_ge_u32 s50, 432
    s_cselect_b32 s10, 0, s10
    s_add_u32 s8, s42, s47
    s_addc_u32 s9, s43, 0
    s_mul_i32 s55, s55, s54
    s_mov_b32 s51, 0
    s_mov_b32 s52, 0
    s_lshl_b32 s38, s45, 8
    s_add_u32 s38, s38, 161792
    s_cmp_eq_u32 s35, 2
    s_cselect_b64 vcc, -1, 0
    s_cselect_b32 s39, 9, 10
    s_lshl_b32 s39, s44, s39
    s_add_u32 s39, s39, 159744
    v_lshlrev_b32 v4, 3, v2
    v_lshlrev_b32 v5, 4, v3
    v_lshlrev_b32 v6, 2, v2
    v_cndmask_b32 v4, v4, v5, vcc
    v_cndmask_b32 v6, v5, v6, vcc
    v_add_u32 v240, s39, v4
    v_add_u32 v241, s38, v6
    v_lshrrev_b32 v4, 2, v2
    v_cndmask_b32 v8, v3, v4, vcc
    v_add_u32 v8, s50, v8
    v_and_b32 v4, 3, v2
    v_lshlrev_b32 v4, 4, v4
    v_lshl_add_u32 v4, v3, 6, v4
    v_add_u32 v4, 1280, v4
    v_lshlrev_b32 v5, 4, v2
    v_cndmask_b32 v7, v5, v4, vcc
    v_add_u32 v4, 0, v8
    v_mul_u32_u24 v5, 205, v4
    v_lshrrev_b32 v5, 10, v5
    v_mul_u32_u24 v6, 5, v5
    v_sub_u32 v4, v4, v6
    v_mul_lo_u32 v5, v5, s46
    v_add_u32 v5, v5, v7
    v_lshl_add_u32 v236, v4, 8, v5
    v_add_u32 v4, 4, v8
    v_mul_u32_u24 v5, 205, v4
    v_lshrrev_b32 v5, 10, v5
    v_mul_u32_u24 v6, 5, v5
    v_sub_u32 v4, v4, v6
    v_mul_lo_u32 v5, v5, s46
    v_add_u32 v5, v5, v7
    v_lshl_add_u32 v237, v4, 8, v5
    v_add_u32 v4, 8, v8
    v_mul_u32_u24 v5, 205, v4
    v_lshrrev_b32 v5, 10, v5
    v_mul_u32_u24 v6, 5, v5
    v_sub_u32 v4, v4, v6
    v_mul_lo_u32 v5, v5, s46
    v_add_u32 v5, v5, v7
    v_lshl_add_u32 v238, v4, 8, v5
    v_add_u32 v4, 12, v8
    v_mul_u32_u24 v5, 205, v4
    v_lshrrev_b32 v5, 10, v5
    v_mul_u32_u24 v6, 5, v5
    v_sub_u32 v4, v4, v6
    v_mul_lo_u32 v5, v5, s46
    v_add_u32 v5, v5, v7
    v_lshl_add_u32 v239, v4, 8, v5
    v_mov_b32 v0, 0
    v_mov_b32 v1, 0
    v_mov_b32 v2, 0
    v_mov_b32 v3, 0
    v_mov_b32 v4, 0
    v_mov_b32 v5, 0
    v_mov_b32 v6, 0
    v_mov_b32 v7, 0
    v_mov_b32 v8, 0
    v_mov_b32 v9, 0
    v_mov_b32 v10, 0
    v_mov_b32 v11, 0
    v_mov_b32 v12, 0
    v_mov_b32 v13, 0
    v_mov_b32 v14, 0
    v_mov_b32 v15, 0
    v_mov_b32 v16, 0
    v_mov_b32 v17, 0
    v_mov_b32 v18, 0
    v_mov_b32 v19, 0
    v_mov_b32 v20, 0
    v_mov_b32 v21, 0
    v_mov_b32 v22, 0
    v_mov_b32 v23, 0
    v_mov_b32 v24, 0
    v_mov_b32 v25, 0
    v_mov_b32 v26, 0
    v_mov_b32 v27, 0
    v_mov_b32 v28, 0
    v_mov_b32 v29, 0
    v_mov_b32 v30, 0
    v_mov_b32 v31, 0
    v_mov_b32 v32, 0
    v_mov_b32 v33, 0
    v_mov_b32 v34, 0
    v_mov_b32 v35, 0
    v_mov_b32 v36, 0
    v_mov_b32 v37, 0
    v_mov_b32 v38, 0
    v_mov_b32 v39, 0
    v_mov_b32 v40, 0
    v_mov_b32 v41, 0
    v_mov_b32 v42, 0
    v_mov_b32 v43, 0
    v_mov_b32 v44, 0
    v_mov_b32 v45, 0
    v_mov_b32 v46, 0
    v_mov_b32 v47, 0
    v_mov_b32 v48, 0
    v_mov_b32 v49, 0
    v_mov_b32 v50, 0
    v_mov_b32 v51, 0
    v_mov_b32 v52, 0
    v_mov_b32 v53, 0
    v_mov_b32 v54, 0
    v_mov_b32 v55, 0
    v_mov_b32 v56, 0
    v_mov_b32 v57, 0
    v_mov_b32 v58, 0
    v_mov_b32 v59, 0
    v_mov_b32 v60, 0
    v_mov_b32 v61, 0
    v_mov_b32 v62, 0
    v_mov_b32 v63, 0
    v_mov_b32 v64, 0
    v_mov_b32 v65, 0
    v_mov_b32 v66, 0
    v_mov_b32 v67, 0
    v_mov_b32 v68, 0
    v_mov_b32 v69, 0
    v_mov_b32 v70, 0
    v_mov_b32 v71, 0
    v_mov_b32 v72, 0
    v_mov_b32 v73, 0
    v_mov_b32 v74, 0
    v_mov_b32 v75, 0
    v_mov_b32 v76, 0
    v_mov_b32 v77, 0
    v_mov_b32 v78, 0
    v_mov_b32 v79, 0
    v_mov_b32 v80, 0
    v_mov_b32 v81, 0
    v_mov_b32 v82, 0
    v_mov_b32 v83, 0
    v_mov_b32 v84, 0
    v_mov_b32 v85, 0
    v_mov_b32 v86, 0
    v_mov_b32 v87, 0
    v_mov_b32 v88, 0
    v_mov_b32 v89, 0
    v_mov_b32 v90, 0
    v_mov_b32 v91, 0
    v_mov_b32 v92, 0
    v_mov_b32 v93, 0
    v_mov_b32 v94, 0
    v_mov_b32 v95, 0
    v_mov_b32 v96, 0
    v_mov_b32 v97, 0
    v_mov_b32 v98, 0
    v_mov_b32 v99, 0
    v_mov_b32 v100, 0
    v_mov_b32 v101, 0
    v_mov_b32 v102, 0
    v_mov_b32 v103, 0
    v_mov_b32 v104, 0
    v_mov_b32 v105, 0
    v_mov_b32 v106, 0
    v_mov_b32 v107, 0
    v_mov_b32 v108, 0
    v_mov_b32 v109, 0
    v_mov_b32 v110, 0
    v_mov_b32 v111, 0
    v_mov_b32 v112, 0
    v_mov_b32 v113, 0
    v_mov_b32 v114, 0
    v_mov_b32 v115, 0
    v_mov_b32 v116, 0
    v_mov_b32 v117, 0
    v_mov_b32 v118, 0
    v_mov_b32 v119, 0
    v_mov_b32 v120, 0
    v_mov_b32 v121, 0
    v_mov_b32 v122, 0
    v_mov_b32 v123, 0
    v_mov_b32 v124, 0
    v_mov_b32 v125, 0
    v_mov_b32 v126, 0
    v_mov_b32 v127, 0
    v_mov_b32 v242, 162304
    ds_write_b128 v242, v[0:3]
    s_setprio 1
    s_waitcnt vmcnt(1)
    s_cmp_eq_u32 s10, 0
    s_barrier
    s_cbranch_scc1 L_idle
    ds_read_b64_tr_b16 v[192:193], v226 offset:32768
    ds_read_b64_tr_b16 v[194:195], v226 offset:33792
    ds_read_b128 v[128:131], v224 offset:0
    ds_read_b128 v[132:135], v224 offset:2048
    ds_read_b128 v[136:139], v224 offset:4096
    ds_read_b128 v[140:143], v224 offset:6144
    ds_read_b128 v[144:147], v224 offset:8192
    ds_read_b128 v[148:151], v224 offset:10240
    ds_read_b128 v[152:155], v224 offset:12288
    ds_read_b128 v[156:159], v224 offset:14336
    ds_read_b64_tr_b16 v[196:197], v227 offset:32768
    ds_read_b64_tr_b16 v[198:199], v227 offset:33792
    ds_read_b64_tr_b16 v[200:201], v228 offset:32768
    ds_read_b64_tr_b16 v[202:203], v228 offset:33792
    ds_read_b64_tr_b16 v[204:205], v229 offset:32768
    ds_read_b64_tr_b16 v[206:207], v229 offset:33792
    s_cmp_eq_u32 s35, 2
    s_waitcnt lgkmcnt(0)
    s_cbranch_scc1 L_loopV
.p2align 5
L_loopN:
    v_mfma_f32_16x16x32_bf16 v[0:3], v[192:195], v[128:131], v[0:3]
    ds_read_b64_tr_b16 v[208:209], v226 offset:40960
    v_mfma_f32_16x16x32_bf16 v[16:19], v[192:195], v[132:135], v[16:19]
    ds_read_b64_tr_b16 v[210:211], v226 offset:41984
    v_mfma_f32_16x16x32_bf16 v[32:35], v[192:195], v[136:139], v[32:35]
    ds_read_b128 v[160:163], v225 offset:0
    v_mfma_f32_16x16x32_bf16 v[48:51], v[192:195], v[140:143], v[48:51]
    ds_read_b128 v[164:167], v225 offset:2048
    v_mfma_f32_16x16x32_bf16 v[64:67], v[192:195], v[144:147], v[64:67]
    ds_read_b128 v[168:171], v225 offset:4096
    v_mfma_f32_16x16x32_bf16 v[80:83], v[192:195], v[148:151], v[80:83]
    ds_read_b128 v[172:175], v225 offset:6144
    v_mfma_f32_16x16x32_bf16 v[96:99], v[192:195], v[152:155], v[96:99]
    ds_read_b128 v[176:179], v225 offset:8192
    v_mfma_f32_16x16x32_bf16 v[112:115], v[192:195], v[156:159], v[112:115]
    ds_read_b128 v[180:183], v225 offset:10240
    v_mfma_f32_16x16x32_bf16 v[4:7], v[196:199], v[128:131], v[4:7]
    ds_read_b128 v[184:187], v225 offset:12288
    v_mfma_f32_16x16x32_bf16 v[20:23], v[196:199], v[132:135], v[20:23]
    ds_read_b128 v[188:191], v225 offset:14336
    v_mfma_f32_16x16x32_bf16 v[36:39], v[196:199], v[136:139], v[36:39]
    ds_read_b64_tr_b16 v[212:213], v227 offset:40960
    v_mfma_f32_16x16x32_bf16 v[52:55], v[196:199], v[140:143], v[52:55]
    ds_read_b64_tr_b16 v[214:215], v227 offset:41984
    v_mfma_f32_16x16x32_bf16 v[68:71], v[196:199], v[144:147], v[68:71]
    ds_read_b64_tr_b16 v[216:217], v228 offset:40960
    v_mfma_f32_16x16x32_bf16 v[84:87], v[196:199], v[148:151], v[84:87]
    ds_read_b64_tr_b16 v[218:219], v228 offset:41984
    v_mfma_f32_16x16x32_bf16 v[100:103], v[196:199], v[152:155], v[100:103]
    ds_read_b64_tr_b16 v[220:221], v229 offset:40960
    v_mfma_f32_16x16x32_bf16 v[116:119], v[196:199], v[156:159], v[116:119]
    ds_read_b64_tr_b16 v[222:223], v229 offset:41984
    v_mfma_f32_16x16x32_bf16 v[8:11], v[200:203], v[128:131], v[8:11]
    v_mfma_f32_16x16x32_bf16 v[24:27], v[200:203], v[132:135], v[24:27]
    s_add_u32 s51, s51, 49152
    v_mfma_f32_16x16x32_bf16 v[40:43], v[200:203], v[136:139], v[40:43]
    s_cmp_eq_u32 s51, 147456
    v_mfma_f32_16x16x32_bf16 v[56:59], v[200:203], v[140:143], v[56:59]
    s_cselect_b32 s51, 0, s51
    v_mfma_f32_16x16x32_bf16 v[72:75], v[200:203], v[144:147], v[72:75]
    v_mfma_f32_16x16x32_bf16 v[88:91], v[200:203], v[148:151], v[88:91]
    v_mfma_f32_16x16x32_bf16 v[104:107], v[200:203], v[152:155], v[104:107]
    s_waitcnt lgkmcnt(0)
    v_mfma_f32_16x16x32_bf16 v[120:123], v[200:203], v[156:159], v[120:123]
    s_barrier
    v_mfma_f32_16x16x32_bf16 v[12:15], v[204:207], v[128:131], v[12:15]
    v_add_u32 v226, s51, v232
    v_mfma_f32_16x16x32_bf16 v[28:31], v[204:207], v[132:135], v[28:31]
    v_add_u32 v224, s51, v230
    v_mfma_f32_16x16x32_bf16 v[44:47], v[204:207], v[136:139], v[44:47]
    v_add_u32 v227, s51, v233
    v_mfma_f32_16x16x32_bf16 v[60:63], v[204:207], v[140:143], v[60:63]
    v_add_u32 v228, s51, v234
    v_mfma_f32_16x16x32_bf16 v[76:79], v[204:207], v[144:147], v[76:79]
    v_add_u32 v229, s51, v235
    v_mfma_f32_16x16x32_bf16 v[92:95], v[204:207], v[148:151], v[92:95]
    v_add_u32 v225, s51, v231
    v_mfma_f32_16x16x32_bf16 v[108:111], v[204:207], v[152:155], v[108:111]
    v_mfma_f32_16x16x32_bf16 v[124:127], v[204:207], v[156:159], v[124:127]
    v_mfma_f32_16x16x32_bf16 v[0:3], v[208:211], v[160:163], v[0:3]
    ds_read_b64_tr_b16 v[192:193], v226 offset:32768
    v_mfma_f32_16x16x32_bf16 v[16:19], v[208:211], v[164:167], v[16:19]
    ds_read_b64_tr_b16 v[194:195], v226 offset:33792
    v_mfma_f32_16x16x32_bf16 v[32:35], v[208:211], v[168:171], v[32:35]
    ds_read_b128 v[128:131], v224 offset:0
    v_mfma_f32_16x16x32_bf16 v[48:51], v[208:211], v[172:175], v[48:51]
    ds_read_b128 v[132:135], v224 offset:2048
    v_mfma_f32_16x16x32_bf16 v[64:67], v[208:211], v[176:179], v[64:67]
    ds_read_b128 v[136:139], v224 offset:4096
    v_mfma_f32_16x16x32_bf16 v[80:83], v[208:211], v[180:183], v[80:83]
    ds_read_b128 v[140:143], v224 offset:6144
    v_mfma_f32_16x16x32_bf16 v[96:99], v[208:211], v[184:187], v[96:99]
    ds_read_b128 v[144:147], v224 offset:8192
    v_mfma_f32_16x16x32_bf16 v[112:115], v[208:211], v[188:191], v[112:115]
    ds_read_b128 v[148:151], v224 offset:10240
    v_mfma_f32_16x16x32_bf16 v[4:7], v[212:215], v[160:163], v[4:7]
    ds_read_b128 v[152:155], v224 offset:12288
    v_mfma_f32_16x16x32_bf16 v[20:23], v[212:215], v[164:167], v[20:23]
    ds_read_b128 v[156:159], v224 offset:14336
    v_mfma_f32_16x16x32_bf16 v[36:39], v[212:215], v[168:171], v[36:39]
    ds_read_b64_tr_b16 v[196:197], v227 offset:32768
    v_mfma_f32_16x16x32_bf16 v[52:55], v[212:215], v[172:175], v[52:55]
    ds_read_b64_tr_b16 v[198:199], v227 offset:33792
    v_mfma_f32_16x16x32_bf16 v[68:71], v[212:215], v[176:179], v[68:71]
    ds_read_b64_tr_b16 v[200:201], v228 offset:32768
    v_mfma_f32_16x16x32_bf16 v[84:87], v[212:215], v[180:183], v[84:87]
    ds_read_b64_tr_b16 v[202:203], v228 offset:33792
    v_mfma_f32_16x16x32_bf16 v[100:103], v[212:215], v[184:187], v[100:103]
    ds_read_b64_tr_b16 v[204:205], v229 offset:32768
    v_mfma_f32_16x16x32_bf16 v[116:119], v[212:215], v[188:191], v[116:119]
    ds_read_b64_tr_b16 v[206:207], v229 offset:33792
    v_mfma_f32_16x16x32_bf16 v[8:11], v[216:219], v[160:163], v[8:11]
    v_mfma_f32_16x16x32_bf16 v[24:27], v[216:219], v[164:167], v[24:27]
    v_mfma_f32_16x16x32_bf16 v[40:43], v[216:219], v[168:171], v[40:43]
    v_mfma_f32_16x16x32_bf16 v[56:59], v[216:219], v[172:175], v[56:59]
    v_mfma_f32_16x16x32_bf16 v[72:75], v[216:219], v[176:179], v[72:75]
    v_mfma_f32_16x16x32_bf16 v[88:91], v[216:219], v[180:183], v[88:91]
    v_mfma_f32_16x16x32_bf16 v[104:107], v[216:219], v[184:187], v[104:107]
    v_mfma_f32_16x16x32_bf16 v[120:123], v[216:219], v[188:191], v[120:123]
    v_mfma_f32_16x16x32_bf16 v[12:15], v[220:223], v[160:163], v[12:15]
    v_mfma_f32_16x16x32_bf16 v[28:31], v[220:223], v[164:167], v[28:31]
    v_mfma_f32_16x16x32_bf16 v[44:47], v[220:223], v[168:171], v[44:47]
    s_add_u32 s52, s52, 1
    v_mfma_f32_16x16x32_bf16 v[60:63], v[220:223], v[172:175], v[60:63]
    s_cmp_lt_u32 s52, 10
    v_mfma_f32_16x16x32_bf16 v[76:79], v[220:223], v[176:179], v[76:79]
    v_mfma_f32_16x16x32_bf16 v[92:95], v[220:223], v[180:183], v[92:95]
    s_waitcnt lgkmcnt(0)
    v_mfma_f32_16x16x32_bf16 v[108:111], v[220:223], v[184:187], v[108:111]
    v_mfma_f32_16x16x32_bf16 v[124:127], v[220:223], v[188:191], v[124:127]
    s_cbranch_scc1 L_loopN
    s_cmp_eq_u32 s35, 3
    s_cbranch_scc1 L_epiH
    s_branch L_epiN
.p2align 5
L_loopV:
    v_mfma_f32_16x16x32_bf16 v[0:3], v[128:131], v[192:195], v[0:3]
    ds_read_b64_tr_b16 v[208:209], v226 offset:40960
    v_mfma_f32_16x16x32_bf16 v[16:19], v[132:135], v[192:195], v[16:19]
    ds_read_b64_tr_b16 v[210:211], v226 offset:41984
    v_mfma_f32_16x16x32_bf16 v[32:35], v[136:139], v[192:195], v[32:35]
    ds_read_b128 v[160:163], v225 offset:0
    v_mfma_f32_16x16x32_bf16 v[48:51], v[140:143], v[192:195], v[48:51]
    ds_read_b128 v[164:167], v225 offset:2048
    v_mfma_f32_16x16x32_bf16 v[64:67], v[144:147], v[192:195], v[64:67]
    ds_read_b128 v[168:171], v225 offset:4096
    v_mfma_f32_16x16x32_bf16 v[80:83], v[148:151], v[192:195], v[80:83]
    ds_read_b128 v[172:175], v225 offset:6144
    v_mfma_f32_16x16x32_bf16 v[96:99], v[152:155], v[192:195], v[96:99]
    ds_read_b128 v[176:179], v225 offset:8192
    v_mfma_f32_16x16x32_bf16 v[112:115], v[156:159], v[192:195], v[112:115]
    ds_read_b128 v[180:183], v225 offset:10240
    v_mfma_f32_16x16x32_bf16 v[4:7], v[128:131], v[196:199], v[4:7]
    ds_read_b128 v[184:187], v225 offset:12288
    v_mfma_f32_16x16x32_bf16 v[20:23], v[132:135], v[196:199], v[20:23]
    ds_read_b128 v[188:191], v225 offset:14336
    v_mfma_f32_16x16x32_bf16 v[36:39], v[136:139], v[196:199], v[36:39]
    ds_read_b64_tr_b16 v[212:213], v227 offset:40960
    v_mfma_f32_16x16x32_bf16 v[52:55], v[140:143], v[196:199], v[52:55]
    ds_read_b64_tr_b16 v[214:215], v227 offset:41984
    v_mfma_f32_16x16x32_bf16 v[68:71], v[144:147], v[196:199], v[68:71]
    ds_read_b64_tr_b16 v[216:217], v228 offset:40960
    v_mfma_f32_16x16x32_bf16 v[84:87], v[148:151], v[196:199], v[84:87]
    ds_read_b64_tr_b16 v[218:219], v228 offset:41984
    v_mfma_f32_16x16x32_bf16 v[100:103], v[152:155], v[196:199], v[100:103]
    ds_read_b64_tr_b16 v[220:221], v229 offset:40960
    v_mfma_f32_16x16x32_bf16 v[116:119], v[156:159], v[196:199], v[116:119]
    ds_read_b64_tr_b16 v[222:223], v229 offset:41984
    v_mfma_f32_16x16x32_bf16 v[8:11], v[128:131], v[200:203], v[8:11]
    v_mfma_f32_16x16x32_bf16 v[24:27], v[132:135], v[200:203], v[24:27]
    s_add_u32 s51, s51, 49152
    v_mfma_f32_16x16x32_bf16 v[40:43], v[136:139], v[200:203], v[40:43]
    s_cmp_eq_u32 s51, 147456
    v_mfma_f32_16x16x32_bf16 v[56:59], v[140:143], v[200:203], v[56:59]
    s_cselect_b32 s51, 0, s51
    v_mfma_f32_16x16x32_bf16 v[72:75], v[144:147], v[200:203], v[72:75]
    v_mfma_f32_16x16x32_bf16 v[88:91], v[148:151], v[200:203], v[88:91]
    v_mfma_f32_16x16x32_bf16 v[104:107], v[152:155], v[200:203], v[104:107]
    s_waitcnt lgkmcnt(0)
    v_mfma_f32_16x16x32_bf16 v[120:123], v[156:159], v[200:203], v[120:123]
    s_barrier
    v_mfma_f32_16x16x32_bf16 v[12:15], v[128:131], v[204:207], v[12:15]
    v_add_u32 v226, s51, v232
    v_mfma_f32_16x16x32_bf16 v[28:31], v[132:135], v[204:207], v[28:31]
    v_add_u32 v224, s51, v230
    v_mfma_f32_16x16x32_bf16 v[44:47], v[136:139], v[204:207], v[44:47]
    v_add_u32 v227, s51, v233
    v_mfma_f32_16x16x32_bf16 v[60:63], v[140:143], v[204:207], v[60:63]
    v_add_u32 v228, s51, v234
    v_mfma_f32_16x16x32_bf16 v[76:79], v[144:147], v[204:207], v[76:79]
    v_add_u32 v229, s51, v235
    v_mfma_f32_16x16x32_bf16 v[92:95], v[148:151], v[204:207], v[92:95]
    v_add_u32 v225, s51, v231
    v_mfma_f32_16x16x32_bf16 v[108:111], v[152:155], v[204:207], v[108:111]
    v_mfma_f32_16x16x32_bf16 v[124:127], v[156:159], v[204:207], v[124:127]
    v_mfma_f32_16x16x32_bf16 v[0:3], v[160:163], v[208:211], v[0:3]
    ds_read_b64_tr_b16 v[192:193], v226 offset:32768
    v_mfma_f32_16x16x32_bf16 v[16:19], v[164:167], v[208:211], v[16:19]
    ds_read_b64_tr_b16 v[194:195], v226 offset:33792
    v_mfma_f32_16x16x32_bf16 v[32:35], v[168:171], v[208:211], v[32:35]
    ds_read_b128 v[128:131], v224 offset:0
    v_mfma_f32_16x16x32_bf16 v[48:51], v[172:175], v[208:211], v[48:51]
    ds_read_b128 v[132:135], v224 offset:2048
    v_mfma_f32_16x16x32_bf16 v[64:67], v[176:179], v[208:211], v[64:67]
    ds_read_b128 v[136:139], v224 offset:4096
    v_mfma_f32_16x16x32_bf16 v[80:83], v[180:183], v[208:211], v[80:83]
    ds_read_b128 v[140:143], v224 offset:6144
    v_mfma_f32_16x16x32_bf16 v[96:99], v[184:187], v[208:211], v[96:99]
    ds_read_b128 v[144:147], v224 offset:8192
    v_mfma_f32_16x16x32_bf16 v[112:115], v[188:191], v[208:211], v[112:115]
    ds_read_b128 v[148:151], v224 offset:10240
    v_mfma_f32_16x16x32_bf16 v[4:7], v[160:163], v[212:215], v[4:7]
    ds_read_b128 v[152:155], v224 offset:12288
    v_mfma_f32_16x16x32_bf16 v[20:23], v[164:167], v[212:215], v[20:23]
    ds_read_b128 v[156:159], v224 offset:14336
    v_mfma_f32_16x16x32_bf16 v[36:39], v[168:171], v[212:215], v[36:39]
    ds_read_b64_tr_b16 v[196:197], v227 offset:32768
    v_mfma_f32_16x16x32_bf16 v[52:55], v[172:175], v[212:215], v[52:55]
    ds_read_b64_tr_b16 v[198:199], v227 offset:33792
    v_mfma_f32_16x16x32_bf16 v[68:71], v[176:179], v[212:215], v[68:71]
    ds_read_b64_tr_b16 v[200:201], v228 offset:32768
    v_mfma_f32_16x16x32_bf16 v[84:87], v[180:183], v[212:215], v[84:87]
    ds_read_b64_tr_b16 v[202:203], v228 offset:33792
    v_mfma_f32_16x16x32_bf16 v[100:103], v[184:187], v[212:215], v[100:103]
    ds_read_b64_tr_b16 v[204:205], v229 offset:32768
    v_mfma_f32_16x16x32_bf16 v[116:119], v[188:191], v[212:215], v[116:119]
    ds_read_b64_tr_b16 v[206:207], v229 offset:33792
    v_mfma_f32_16x16x32_bf16 v[8:11], v[160:163], v[216:219], v[8:11]
    v_mfma_f32_16x16x32_bf16 v[24:27], v[164:167], v[216:219], v[24:27]
    v_mfma_f32_16x16x32_bf16 v[40:43], v[168:171], v[216:219], v[40:43]
    v_mfma_f32_16x16x32_bf16 v[56:59], v[172:175], v[216:219], v[56:59]
    v_mfma_f32_16x16x32_bf16 v[72:75], v[176:179], v[216:219], v[72:75]
    v_mfma_f32_16x16x32_bf16 v[88:91], v[180:183], v[216:219], v[88:91]
    v_mfma_f32_16x16x32_bf16 v[104:107], v[184:187], v[216:219], v[104:107]
    v_mfma_f32_16x16x32_bf16 v[120:123], v[188:191], v[216:219], v[120:123]
    v_mfma_f32_16x16x32_bf16 v[12:15], v[160:163], v[220:223], v[12:15]
    v_mfma_f32_16x16x32_bf16 v[28:31], v[164:167], v[220:223], v[28:31]
    v_mfma_f32_16x16x32_bf16 v[44:47], v[168:171], v[220:223], v[44:47]
    s_add_u32 s52, s52, 1
    v_mfma_f32_16x16x32_bf16 v[60:63], v[172:175], v[220:223], v[60:63]
    s_cmp_lt_u32 s52, 10
    v_mfma_f32_16x16x32_bf16 v[76:79], v[176:179], v[220:223], v[76:79]
    v_mfma_f32_16x16x32_bf16 v[92:95], v[180:183], v[220:223], v[92:95]
    s_waitcnt lgkmcnt(0)
    v_mfma_f32_16x16x32_bf16 v[108:111], v[184:187], v[220:223], v[108:111]
    v_mfma_f32_16x16x32_bf16 v[124:127], v[188:191], v[220:223], v[124:127]
    s_cbranch_scc1 L_loopV
    s_branch L_epiV
L_epiN:
    s_barrier
L_epiN0:
    ds_read_b64 v[128:129], v240 offset:0
    ds_read_b64 v[130:131], v240 offset:128
    ds_read_b128 v[144:147], v241 offset:0
    ds_read_b128 v[148:151], v241 offset:64
    ds_read_b128 v[152:155], v241 offset:128
    ds_read_b128 v[156:159], v241 offset:192
    ds_read_b64 v[132:133], v240 offset:256
    ds_read_b64 v[134:135], v240 offset:384
    ds_read_b64 v[136:137], v240 offset:512
    ds_read_b64 v[138:139], v240 offset:640
    ds_read_b64 v[140:141], v240 offset:768
    ds_read_b64 v[142:143], v240 offset:896
    s_waitcnt lgkmcnt(9)
    v_pk_fma_f32 v[0:1], v[144:145], v[128:129], v[0:1] op_sel:[0,1,0] op_sel_hi:[1,1,1]
    v_pk_fma_f32 v[2:3], v[146:147], v[128:129], v[2:3] op_sel:[0,1,0] op_sel_hi:[1,1,1]
    v_pk_fma_f32 v[16:17], v[144:145], v[130:131], v[16:17] op_sel:[0,1,0] op_sel_hi:[1,1,1]
    v_pk_fma_f32 v[18:19], v[146:147], v[130:131], v[18:19] op_sel:[0,1,0] op_sel_hi:[1,1,1]
    v_pk_mul_f32 v[0:1], v[0:1], v[128:129] op_sel:[0,0] op_sel_hi:[1,0]
    v_pk_mul_f32 v[2:3], v[2:3], v[128:129] op_sel:[0,0] op_sel_hi:[1,0]
    v_pk_mul_f32 v[16:17], v[16:17], v[130:131] op_sel:[0,0] op_sel_hi:[1,0]
    v_pk_mul_f32 v[18:19], v[18:19], v[130:131] op_sel:[0,0] op_sel_hi:[1,0]
    v_cvt_pk_bf16_f32 v212, v0, v1
    v_cvt_pk_bf16_f32 v213, v2, v3
    v_cvt_pk_bf16_f32 v214, v16, v17
    v_cvt_pk_bf16_f32 v215, v18, v19
    buffer_store_dwordx4 v[212:215], v236, s[8:11], s55 offen sc1
    s_waitcnt lgkmcnt(8)
    v_pk_fma_f32 v[4:5], v[148:149], v[128:129], v[4:5] op_sel:[0,1,0] op_sel_hi:[1,1,1]
    v_pk_fma_f32 v[6:7], v[150:151], v[128:129], v[6:7] op_sel:[0,1,0] op_sel_hi:[1,1,1]
    v_pk_fma_f32 v[20:21], v[148:149], v[130:131], v[20:21] op_sel:[0,1,0] op_sel_hi:[1,1,1]
    v_pk_fma_f32 v[22:23], v[150:151], v[130:131], v[22:23] op_sel:[0,1,0] op_sel_hi:[1,1,1]
    v_pk_mul_f32 v[4:5], v[4:5], v[128:129] op_sel:[0,0] op_sel_hi:[1,0]
    v_pk_mul_f32 v[6:7], v[6:7], v[128:129] op_sel:[0,0] op_sel_hi:[1,0]
    v_pk_mul_f32 v[20:21], v[20:21], v[130:131] op_sel:[0,0] op_sel_hi:[1,0]
    v_pk_mul_f32 v[22:23], v[22:23], v[130:131] op_sel:[0,0] op_sel_hi:[1,0]
    v_cvt_pk_bf16_f32 v216, v4, v5
    v_cvt_pk_bf16_f32 v217, v6, v7
    v_cvt_pk_bf16_f32 v218, v20, v21
    v_cvt_pk_bf16_f32 v219, v22, v23
    buffer_store_dwordx4 v[216:219], v237, s[8:11], s55 offen sc1
    s_waitcnt lgkmcnt(7)
    v_pk_fma_f32 v[8:9], v[152:153], v[128:129], v[8:9] op_sel:[0,1,0] op_sel_hi:[1,1,1]
    v_pk_fma_f32 v[10:11], v[154:155], v[128:129], v[10:11] op_sel:[0,1,0] op_sel_hi:[1,1,1]
    v_pk_fma_f32 v[24:25], v[152:153], v[130:131], v[24:25] op_sel:[0,1,0] op_sel_hi:[1,1,1]
    v_pk_fma_f32 v[26:27], v[154:155], v[130:131], v[26:27] op_sel:[0,1,0] op_sel_hi:[1,1,1]
    v_pk_mul_f32 v[8:9], v[8:9], v[128:129] op_sel:[0,0] op_sel_hi:[1,0]
    v_pk_mul_f32 v[10:11], v[10:11], v[128:129] op_sel:[0,0] op_sel_hi:[1,0]
    v_pk_mul_f32 v[24:25], v[24:25], v[130:131] op_sel:[0,0] op_sel_hi:[1,0]
    v_pk_mul_f32 v[26:27], v[26:27], v[130:131] op_sel:[0,0] op_sel_hi:[1,0]
    v_cvt_pk_bf16_f32 v220, v8, v9
    v_cvt_pk_bf16_f32 v221, v10, v11
    v_cvt_pk_bf16_f32 v222, v24, v25
    v_cvt_pk_bf16_f32 v223, v26, v27
    buffer_store_dwordx4 v[220:223], v238, s[8:11], s55 offen sc1
    s_waitcnt lgkmcnt(6)
    v_pk_fma_f32 v[12:13], v[156:157], v[128:129], v[12:13] op_sel:[0,1,0] op_sel_hi:[1,1,1]
    v_pk_fma_f32 v[14:15], v[158:159], v[128:129], v[14:15] op_sel:[0,1,0] op_sel_hi:[1,1,1]
    v_pk_fma_f32 v[28:29], v[156:157], v[130:131], v[28:29] op_sel:[0,1,0] op_sel_hi:[1,1,1]
    v_pk_fma_f32 v[30:31], v[158:159], v[130:131], v[30:31] op_sel:[0,1,0] op_sel_hi:[1,1,1]
    v_pk_mul_f32 v[12:13], v[12:13], v[128:129] op_sel:[0,0] op_sel_hi:[1,0]
    v_pk_mul_f32 v[14:15], v[14:15], v[128:129] op_sel:[0,0] op_sel_hi:[1,0]
    v_pk_mul_f32 v[28:29], v[28:29], v[130:131] op_sel:[0,0] op_sel_hi:[1,0]
    v_pk_mul_f32 v[30:31], v[30:31], v[130:131] op_sel:[0,0] op_sel_hi:[1,0]
    v_cvt_pk_bf16_f32 v224, v12, v13
    v_cvt_pk_bf16_f32 v225, v14, v15
    v_cvt_pk_bf16_f32 v226, v28, v29
    v_cvt_pk_bf16_f32 v227, v30, v31
    buffer_store_dwordx4 v[224:227], v239, s[8:11], s55 offen sc1
    s_add_u32 s55, s55, s54
L_epiN1:
    s_waitcnt lgkmcnt(0)
    v_pk_fma_f32 v[32:33], v[144:145], v[132:133], v[32:33] op_sel:[0,1,0] op_sel_hi:[1,1,1]
    v_pk_fma_f32 v[34:35], v[146:147], v[132:133], v[34:35] op_sel:[0,1,0] op_sel_hi:[1,1,1]
    v_pk_fma_f32 v[48:49], v[144:145], v[134:135], v[48:49] op_sel:[0,1,0] op_sel_hi:[1,1,1]
    v_pk_fma_f32 v[50:51], v[146:147], v[134:135], v[50:51] op_sel:[0,1,0] op_sel_hi:[1,1,1]
    v_pk_mul_f32 v[32:33], v[32:33], v[132:133] op_sel:[0,0] op_sel_hi:[1,0]
    v_pk_mul_f32 v[34:35], v[34:35], v[132:133] op_sel:[0,0] op_sel_hi:[1,0]
    v_pk_mul_f32 v[48:49], v[48:49], v[134:135] op_sel:[0,0] op_sel_hi:[1,0]
    v_pk_mul_f32 v[50:51], v[50:51], v[134:135] op_sel:[0,0] op_sel_hi:[1,0]
    v_cvt_pk_bf16_f32 v212, v32, v33
    v_cvt_pk_bf16_f32 v213, v34, v35
    v_cvt_pk_bf16_f32 v214, v48, v49
    v_cvt_pk_bf16_f32 v215, v50, v51
    buffer_store_dwordx4 v[212:215], v236, s[8:11], s55 offen sc1
    v_pk_fma_f32 v[36:37], v[148:149], v[132:133], v[36:37] op_sel:[0,1,0] op_sel_hi:[1,1,1]
    v_pk_fma_f32 v[38:39], v[150:151], v[132:133], v[38:39] op_sel:[0,1,0] op_sel_hi:[1,1,1]
    v_pk_fma_f32 v[52:53], v[148:149], v[134:135], v[52:53] op_sel:[0,1,0] op_sel_hi:[1,1,1]
    v_pk_fma_f32 v[54:55], v[150:151], v[134:135], v[54:55] op_sel:[0,1,0] op_sel_hi:[1,1,1]
    v_pk_mul_f32 v[36:37], v[36:37], v[132:133] op_sel:[0,0] op_sel_hi:[1,0]
    v_pk_mul_f32 v[38:39], v[38:39], v[132:133] op_sel:[0,0] op_sel_hi:[1,0]
    v_pk_mul_f32 v[52:53], v[52:53], v[134:135] op_sel:[0,0] op_sel_hi:[1,0]
    v_pk_mul_f32 v[54:55], v[54:55], v[134:135] op_sel:[0,0] op_sel_hi:[1,0]
    v_cvt_pk_bf16_f32 v216, v36, v37
    v_cvt_pk_bf16_f32 v217, v38, v39
    v_cvt_pk_bf16_f32 v218, v52, v53
    v_cvt_pk_bf16_f32 v219, v54, v55
    buffer_store_dwordx4 v[216:219], v237, s[8:11], s55 offen sc1
    v_pk_fma_f32 v[40:41], v[152:153], v[132:133], v[40:41] op_sel:[0,1,0] op_sel_hi:[1,1,1]
    v_pk_fma_f32 v[42:43], v[154:155], v[132:133], v[42:43] op_sel:[0,1,0] op_sel_hi:[1,1,1]
    v_pk_fma_f32 v[56:57], v[152:153], v[134:135], v[56:57] op_sel:[0,1,0] op_sel_hi:[1,1,1]
    v_pk_fma_f32 v[58:59], v[154:155], v[134:135], v[58:59] op_sel:[0,1,0] op_sel_hi:[1,1,1]
    v_pk_mul_f32 v[40:41], v[40:41], v[132:133] op_sel:[0,0] op_sel_hi:[1,0]
    v_pk_mul_f32 v[42:43], v[42:43], v[132:133] op_sel:[0,0] op_sel_hi:[1,0]
    v_pk_mul_f32 v[56:57], v[56:57], v[134:135] op_sel:[0,0] op_sel_hi:[1,0]
    v_pk_mul_f32 v[58:59], v[58:59], v[134:135] op_sel:[0,0] op_sel_hi:[1,0]
    v_cvt_pk_bf16_f32 v220, v40, v41
    v_cvt_pk_bf16_f32 v221, v42, v43
    v_cvt_pk_bf16_f32 v222, v56, v57
    v_cvt_pk_bf16_f32 v223, v58, v59
    buffer_store_dwordx4 v[220:223], v238, s[8:11], s55 offen sc1
    v_pk_fma_f32 v[44:45], v[156:157], v[132:133], v[44:45] op_sel:[0,1,0] op_sel_hi:[1,1,1]
    v_pk_fma_f32 v[46:47], v[158:159], v[132:133], v[46:47] op_sel:[0,1,0] op_sel_hi:[1,1,1]
    v_pk_fma_f32 v[60:61], v[156:157], v[134:135], v[60:61] op_sel:[0,1,0] op_sel_hi:[1,1,1]
    v_pk_fma_f32 v[62:63], v[158:159], v[134:135], v[62:63] op_sel:[0,1,0] op_sel_hi:[1,1,1]
    v_pk_mul_f32 v[44:45], v[44:45], v[132:133] op_sel:[0,0] op_sel_hi:[1,0]
    v_pk_mul_f32 v[46:47], v[46:47], v[132:133] op_sel:[0,0] op_sel_hi:[1,0]
    v_pk_mul_f32 v[60:61], v[60:61], v[134:135] op_sel:[0,0] op_sel_hi:[1,0]
    v_pk_mul_f32 v[62:63], v[62:63], v[134:135] op_sel:[0,0] op_sel_hi:[1,0]
    v_cvt_pk_bf16_f32 v224, v44, v45
    v_cvt_pk_bf16_f32 v225, v46, v47
    v_cvt_pk_bf16_f32 v226, v60, v61
    v_cvt_pk_bf16_f32 v227, v62, v63
    buffer_store_dwordx4 v[224:227], v239, s[8:11], s55 offen sc1
    s_add_u32 s55, s55, s54
L_epiN2:
    v_pk_fma_f32 v[64:65], v[144:145], v[136:137], v[64:65] op_sel:[0,1,0] op_sel_hi:[1,1,1]
    v_pk_fma_f32 v[66:67], v[146:147], v[136:137], v[66:67] op_sel:[0,1,0] op_sel_hi:[1,1,1]
    v_pk_fma_f32 v[80:81], v[144:145], v[138:139], v[80:81] op_sel:[0,1,0] op_sel_hi:[1,1,1]
    v_pk_fma_f32 v[82:83], v[146:147], v[138:139], v[82:83] op_sel:[0,1,0] op_sel_hi:[1,1,1]
    v_pk_mul_f32 v[64:65], v[64:65], v[136:137] op_sel:[0,0] op_sel_hi:[1,0]
    v_pk_mul_f32 v[66:67], v[66:67], v[136:137] op_sel:[0,0] op_sel_hi:[1,0]
    v_pk_mul_f32 v[80:81], v[80:81], v[138:139] op_sel:[0,0] op_sel_hi:[1,0]
    v_pk_mul_f32 v[82:83], v[82:83], v[138:139] op_sel:[0,0] op_sel_hi:[1,0]
    v_cvt_pk_bf16_f32 v212, v64, v65
    v_cvt_pk_bf16_f32 v213, v66, v67
    v_cvt_pk_bf16_f32 v214, v80, v81
    v_cvt_pk_bf16_f32 v215, v82, v83
    buffer_store_dwordx4 v[212:215], v236, s[8:11], s55 offen sc1
    v_pk_fma_f32 v[68:69], v[148:149], v[136:137], v[68:69] op_sel:[0,1,0] op_sel_hi:[1,1,1]
    v_pk_fma_f32 v[70:71], v[150:151], v[136:137], v[70:71] op_sel:[0,1,0] op_sel_hi:[1,1,1]
    v_pk_fma_f32 v[84:85], v[148:149], v[138:139], v[84:85] op_sel:[0,1,0] op_sel_hi:[1,1,1]
    v_pk_fma_f32 v[86:87], v[150:151], v[138:139], v[86:87] op_sel:[0,1,0] op_sel_hi:[1,1,1]
    v_pk_mul_f32 v[68:69], v[68:69], v[136:137] op_sel:[0,0] op_sel_hi:[1,0]
    v_pk_mul_f32 v[70:71], v[70:71], v[136:137] op_sel:[0,0] op_sel_hi:[1,0]
    v_pk_mul_f32 v[84:85], v[84:85], v[138:139] op_sel:[0,0] op_sel_hi:[1,0]
    v_pk_mul_f32 v[86:87], v[86:87], v[138:139] op_sel:[0,0] op_sel_hi:[1,0]
    v_cvt_pk_bf16_f32 v216, v68, v69
    v_cvt_pk_bf16_f32 v217, v70, v71
    v_cvt_pk_bf16_f32 v218, v84, v85
    v_cvt_pk_bf16_f32 v219, v86, v87
    buffer_store_dwordx4 v[216:219], v237, s[8:11], s55 offen sc1
    v_pk_fma_f32 v[72:73], v[152:153], v[136:137], v[72:73] op_sel:[0,1,0] op_sel_hi:[1,1,1]
    v_pk_fma_f32 v[74:75], v[154:155], v[136:137], v[74:75] op_sel:[0,1,0] op_sel_hi:[1,1,1]
    v_pk_fma_f32 v[88:89], v[152:153], v[138:139], v[88:89] op_sel:[0,1,0] op_sel_hi:[1,1,1]
    v_pk_fma_f32 v[90:91], v[154:155], v[138:139], v[90:91] op_sel:[0,1,0] op_sel_hi:[1,1,1]
    v_pk_mul_f32 v[72:73], v[72:73], v[136:137] op_sel:[0,0] op_sel_hi:[1,0]
    v_pk_mul_f32 v[74:75], v[74:75], v[136:137] op_sel:[0,0] op_sel_hi:[1,0]
    v_pk_mul_f32 v[88:89], v[88:89], v[138:139] op_sel:[0,0] op_sel_hi:[1,0]
    v_pk_mul_f32 v[90:91], v[90:91], v[138:139] op_sel:[0,0] op_sel_hi:[1,0]
    v_cvt_pk_bf16_f32 v220, v72, v73
    v_cvt_pk_bf16_f32 v221, v74, v75
    v_cvt_pk_bf16_f32 v222, v88, v89
    v_cvt_pk_bf16_f32 v223, v90, v91
    buffer_store_dwordx4 v[220:223], v238, s[8:11], s55 offen sc1
    v_pk_fma_f32 v[76:77], v[156:157], v[136:137], v[76:77] op_sel:[0,1,0] op_sel_hi:[1,1,1]
    v_pk_fma_f32 v[78:79], v[158:159], v[136:137], v[78:79] op_sel:[0,1,0] op_sel_hi:[1,1,1]
    v_pk_fma_f32 v[92:93], v[156:157], v[138:139], v[92:93] op_sel:[0,1,0] op_sel_hi:[1,1,1]
    v_pk_fma_f32 v[94:95], v[158:159], v[138:139], v[94:95] op_sel:[0,1,0] op_sel_hi:[1,1,1]
    v_pk_mul_f32 v[76:77], v[76:77], v[136:137] op_sel:[0,0] op_sel_hi:[1,0]
    v_pk_mul_f32 v[78:79], v[78:79], v[136:137] op_sel:[0,0] op_sel_hi:[1,0]
    v_pk_mul_f32 v[92:93], v[92:93], v[138:139] op_sel:[0,0] op_sel_hi:[1,0]
    v_pk_mul_f32 v[94:95], v[94:95], v[138:139] op_sel:[0,0] op_sel_hi:[1,0]
    v_cvt_pk_bf16_f32 v224, v76, v77
    v_cvt_pk_bf16_f32 v225, v78, v79
    v_cvt_pk_bf16_f32 v226, v92, v93
    v_cvt_pk_bf16_f32 v227, v94, v95
    buffer_store_dwordx4 v[224:227], v239, s[8:11], s55 offen sc1
    s_add_u32 s55, s55, s54
L_epiN3:
    v_pk_fma_f32 v[96:97], v[144:145], v[140:141], v[96:97] op_sel:[0,1,0] op_sel_hi:[1,1,1]
    v_pk_fma_f32 v[98:99], v[146:147], v[140:141], v[98:99] op_sel:[0,1,0] op_sel_hi:[1,1,1]
    v_pk_fma_f32 v[112:113], v[144:145], v[142:143], v[112:113] op_sel:[0,1,0] op_sel_hi:[1,1,1]
    v_pk_fma_f32 v[114:115], v[146:147], v[142:143], v[114:115] op_sel:[0,1,0] op_sel_hi:[1,1,1]
    v_pk_mul_f32 v[96:97], v[96:97], v[140:141] op_sel:[0,0] op_sel_hi:[1,0]
    v_pk_mul_f32 v[98:99], v[98:99], v[140:141] op_sel:[0,0] op_sel_hi:[1,0]
    v_pk_mul_f32 v[112:113], v[112:113], v[142:143] op_sel:[0,0] op_sel_hi:[1,0]
    v_pk_mul_f32 v[114:115], v[114:115], v[142:143] op_sel:[0,0] op_sel_hi:[1,0]
    v_cvt_pk_bf16_f32 v212, v96, v97
    v_cvt_pk_bf16_f32 v213, v98, v99
    v_cvt_pk_bf16_f32 v214, v112, v113
    v_cvt_pk_bf16_f32 v215, v114, v115
    buffer_store_dwordx4 v[212:215], v236, s[8:11], s55 offen sc1
    v_pk_fma_f32 v[100:101], v[148:149], v[140:141], v[100:101] op_sel:[0,1,0] op_sel_hi:[1,1,1]
    v_pk_fma_f32 v[102:103], v[150:151], v[140:141], v[102:103] op_sel:[0,1,0] op_sel_hi:[1,1,1]
    v_pk_fma_f32 v[116:117], v[148:149], v[142:143], v[116:117] op_sel:[0,1,0] op_sel_hi:[1,1,1]
    v_pk_fma_f32 v[118:119], v[150:151], v[142:143], v[118:119] op_sel:[0,1,0] op_sel_hi:[1,1,1]
    v_pk_mul_f32 v[100:101], v[100:101], v[140:141] op_sel:[0,0] op_sel_hi:[1,0]
    v_pk_mul_f32 v[102:103], v[102:103], v[140:141] op_sel:[0,0] op_sel_hi:[1,0]
    v_pk_mul_f32 v[116:117], v[116:117], v[142:143] op_sel:[0,0] op_sel_hi:[1,0]
    v_pk_mul_f32 v[118:119], v[118:119], v[142:143] op_sel:[0,0] op_sel_hi:[1,0]
    v_cvt_pk_bf16_f32 v216, v100, v101
    v_cvt_pk_bf16_f32 v217, v102, v103
    v_cvt_pk_bf16_f32 v218, v116, v117
    v_cvt_pk_bf16_f32 v219, v118, v119
    buffer_store_dwordx4 v[216:219], v237, s[8:11], s55 offen sc1
    v_pk_fma_f32 v[104:105], v[152:153], v[140:141], v[104:105] op_sel:[0,1,0] op_sel_hi:[1,1,1]
    v_pk_fma_f32 v[106:107], v[154:155], v[140:141], v[106:107] op_sel:[0,1,0] op_sel_hi:[1,1,1]
    v_pk_fma_f32 v[120:121], v[152:153], v[142:143], v[120:121] op_sel:[0,1,0] op_sel_hi:[1,1,1]
    v_pk_fma_f32 v[122:123], v[154:155], v[142:143], v[122:123] op_sel:[0,1,0] op_sel_hi:[1,1,1]
    v_pk_mul_f32 v[104:105], v[104:105], v[140:141] op_sel:[0,0] op_sel_hi:[1,0]
    v_pk_mul_f32 v[106:107], v[106:107], v[140:141] op_sel:[0,0] op_sel_hi:[1,0]
    v_pk_mul_f32 v[120:121], v[120:121], v[142:143] op_sel:[0,0] op_sel_hi:[1,0]
    v_pk_mul_f32 v[122:123], v[122:123], v[142:143] op_sel:[0,0] op_sel_hi:[1,0]
    v_cvt_pk_bf16_f32 v220, v104, v105
    v_cvt_pk_bf16_f32 v221, v106, v107
    v_cvt_pk_bf16_f32 v222, v120, v121
    v_cvt_pk_bf16_f32 v223, v122, v123
    buffer_store_dwordx4 v[220:223], v238, s[8:11], s55 offen sc1
    v_pk_fma_f32 v[108:109], v[156:157], v[140:141], v[108:109] op_sel:[0,1,0] op_sel_hi:[1,1,1]
    v_pk_fma_f32 v[110:111], v[158:159], v[140:141], v[110:111] op_sel:[0,1,0] op_sel_hi:[1,1,1]
    v_pk_fma_f32 v[124:125], v[156:157], v[142:143], v[124:125] op_sel:[0,1,0] op_sel_hi:[1,1,1]
    v_pk_fma_f32 v[126:127], v[158:159], v[142:143], v[126:127] op_sel:[0,1,0] op_sel_hi:[1,1,1]
    v_pk_mul_f32 v[108:109], v[108:109], v[140:141] op_sel:[0,0] op_sel_hi:[1,0]
    v_pk_mul_f32 v[110:111], v[110:111], v[140:141] op_sel:[0,0] op_sel_hi:[1,0]
    v_pk_mul_f32 v[124:125], v[124:125], v[142:143] op_sel:[0,0] op_sel_hi:[1,0]
    v_pk_mul_f32 v[126:127], v[126:127], v[142:143] op_sel:[0,0] op_sel_hi:[1,0]
    v_cvt_pk_bf16_f32 v224, v108, v109
    v_cvt_pk_bf16_f32 v225, v110, v111
    v_cvt_pk_bf16_f32 v226, v124, v125
    v_cvt_pk_bf16_f32 v227, v126, v127
    buffer_store_dwordx4 v[224:227], v239, s[8:11], s55 offen sc1
    s_branch L_epi_done
L_epiH:
    s_barrier
L_epiH0:
    ds_read_b64 v[128:129], v240 offset:0
    ds_read_b64 v[130:131], v240 offset:128
    ds_read_b128 v[144:147], v241 offset:0
    ds_read_b128 v[148:151], v241 offset:64
    ds_read_b128 v[152:155], v241 offset:128
    ds_read_b128 v[156:159], v241 offset:192
    ds_read_b64 v[132:133], v240 offset:256
    ds_read_b64 v[134:135], v240 offset:384
    ds_read_b64 v[136:137], v240 offset:512
    ds_read_b64 v[138:139], v240 offset:640
    ds_read_b64 v[140:141], v240 offset:768
    ds_read_b64 v[142:143], v240 offset:896
    s_waitcnt lgkmcnt(9)
    v_pk_fma_f32 v[0:1], v[144:145], v[128:129], v[0:1] op_sel:[0,1,0] op_sel_hi:[1,1,1]
    v_pk_fma_f32 v[2:3], v[146:147], v[128:129], v[2:3] op_sel:[0,1,0] op_sel_hi:[1,1,1]
    v_pk_fma_f32 v[16:17], v[144:145], v[130:131], v[16:17] op_sel:[0,1,0] op_sel_hi:[1,1,1]
    v_pk_fma_f32 v[18:19], v[146:147], v[130:131], v[18:19] op_sel:[0,1,0] op_sel_hi:[1,1,1]
    v_pk_mul_f32 v[0:1], v[0:1], v[128:129] op_sel:[0,0] op_sel_hi:[1,0]
    v_pk_mul_f32 v[2:3], v[2:3], v[128:129] op_sel:[0,0] op_sel_hi:[1,0]
    v_pk_mul_f32 v[16:17], v[16:17], v[130:131] op_sel:[0,0] op_sel_hi:[1,0]
    v_pk_mul_f32 v[18:19], v[18:19], v[130:131] op_sel:[0,0] op_sel_hi:[1,0]
    v_cvt_pk_bf16_f32 v168, v0, v1
    v_cvt_pk_bf16_f32 v169, v2, v3
    v_cvt_pk_bf16_f32 v170, v16, v17
    v_cvt_pk_bf16_f32 v171, v18, v19
    v_pk_max_i16 v168, v168, 0
    v_pk_max_i16 v169, v169, 0
    v_pk_max_i16 v170, v170, 0
    v_pk_max_i16 v171, v171, 0
    s_waitcnt lgkmcnt(8)
    v_pk_fma_f32 v[4:5], v[148:149], v[128:129], v[4:5] op_sel:[0,1,0] op_sel_hi:[1,1,1]
    v_pk_fma_f32 v[6:7], v[150:151], v[128:129], v[6:7] op_sel:[0,1,0] op_sel_hi:[1,1,1]
    v_pk_fma_f32 v[20:21], v[148:149], v[130:131], v[20:21] op_sel:[0,1,0] op_sel_hi:[1,1,1]
    v_pk_fma_f32 v[22:23], v[150:151], v[130:131], v[22:23] op_sel:[0,1,0] op_sel_hi:[1,1,1]
    v_pk_mul_f32 v[4:5], v[4:5], v[128:129] op_sel:[0,0] op_sel_hi:[1,0]
    v_pk_mul_f32 v[6:7], v[6:7], v[128:129] op_sel:[0,0] op_sel_hi:[1,0]
    v_pk_mul_f32 v[20:21], v[20:21], v[130:131] op_sel:[0,0] op_sel_hi:[1,0]
    v_pk_mul_f32 v[22:23], v[22:23], v[130:131] op_sel:[0,0] op_sel_hi:[1,0]
    v_cvt_pk_bf16_f32 v172, v4, v5
    v_cvt_pk_bf16_f32 v173, v6, v7
    v_cvt_pk_bf16_f32 v174, v20, v21
    v_cvt_pk_bf16_f32 v175, v22, v23
    v_pk_max_i16 v172, v172, 0
    v_pk_max_i16 v173, v173, 0
    v_pk_max_i16 v174, v174, 0
    v_pk_max_i16 v175, v175, 0
    s_waitcnt lgkmcnt(7)
    v_pk_fma_f32 v[8:9], v[152:153], v[128:129], v[8:9] op_sel:[0,1,0] op_sel_hi:[1,1,1]
    v_pk_fma_f32 v[10:11], v[154:155], v[128:129], v[10:11] op_sel:[0,1,0] op_sel_hi:[1,1,1]
    v_pk_fma_f32 v[24:25], v[152:153], v[130:131], v[24:25] op_sel:[0,1,0] op_sel_hi:[1,1,1]
    v_pk_fma_f32 v[26:27], v[154:155], v[130:131], v[26:27] op_sel:[0,1,0] op_sel_hi:[1,1,1]
    v_pk_mul_f32 v[8:9], v[8:9], v[128:129] op_sel:[0,0] op_sel_hi:[1,0]
    v_pk_mul_f32 v[10:11], v[10:11], v[128:129] op_sel:[0,0] op_sel_hi:[1,0]
    v_pk_mul_f32 v[24:25], v[24:25], v[130:131] op_sel:[0,0] op_sel_hi:[1,0]
    v_pk_mul_f32 v[26:27], v[26:27], v[130:131] op_sel:[0,0] op_sel_hi:[1,0]
    v_cvt_pk_bf16_f32 v176, v8, v9
    v_cvt_pk_bf16_f32 v177, v10, v11
    v_cvt_pk_bf16_f32 v178, v24, v25
    v_cvt_pk_bf16_f32 v179, v26, v27
    v_pk_max_i16 v176, v176, 0
    v_pk_max_i16 v177, v177, 0
    v_pk_max_i16 v178, v178, 0
    v_pk_max_i16 v179, v179, 0
    s_waitcnt lgkmcnt(6)
    v_pk_fma_f32 v[12:13], v[156:157], v[128:129], v[12:13] op_sel:[0,1,0] op_sel_hi:[1,1,1]
    v_pk_fma_f32 v[14:15], v[158:159], v[128:129], v[14:15] op_sel:[0,1,0] op_sel_hi:[1,1,1]
    v_pk_fma_f32 v[28:29], v[156:157], v[130:131], v[28:29] op_sel:[0,1,0] op_sel_hi:[1,1,1]
    v_pk_fma_f32 v[30:31], v[158:159], v[130:131], v[30:31] op_sel:[0,1,0] op_sel_hi:[1,1,1]
    v_pk_mul_f32 v[12:13], v[12:13], v[128:129] op_sel:[0,0] op_sel_hi:[1,0]
    v_pk_mul_f32 v[14:15], v[14:15], v[128:129] op_sel:[0,0] op_sel_hi:[1,0]
    v_pk_mul_f32 v[28:29], v[28:29], v[130:131] op_sel:[0,0] op_sel_hi:[1,0]
    v_pk_mul_f32 v[30:31], v[30:31], v[130:131] op_sel:[0,0] op_sel_hi:[1,0]
    v_cvt_pk_bf16_f32 v180, v12, v13
    v_cvt_pk_bf16_f32 v181, v14, v15
    v_cvt_pk_bf16_f32 v182, v28, v29
    v_cvt_pk_bf16_f32 v183, v30, v31
    v_pk_max_i16 v180, v180, 0
    v_pk_max_i16 v181, v181, 0
    v_pk_max_i16 v182, v182, 0
    v_pk_max_i16 v183, v183, 0
L_epiH1:
    s_waitcnt lgkmcnt(0)
    v_pk_fma_f32 v[32:33], v[144:145], v[132:133], v[32:33] op_sel:[0,1,0] op_sel_hi:[1,1,1]
    v_pk_fma_f32 v[34:35], v[146:147], v[132:133], v[34:35] op_sel:[0,1,0] op_sel_hi:[1,1,1]
    v_pk_fma_f32 v[48:49], v[144:145], v[134:135], v[48:49] op_sel:[0,1,0] op_sel_hi:[1,1,1]
    v_pk_fma_f32 v[50:51], v[146:147], v[134:135], v[50:51] op_sel:[0,1,0] op_sel_hi:[1,1,1]
    v_pk_mul_f32 v[32:33], v[32:33], v[132:133] op_sel:[0,0] op_sel_hi:[1,0]
    v_pk_mul_f32 v[34:35], v[34:35], v[132:133] op_sel:[0,0] op_sel_hi:[1,0]
    v_pk_mul_f32 v[48:49], v[48:49], v[134:135] op_sel:[0,0] op_sel_hi:[1,0]
    v_pk_mul_f32 v[50:51], v[50:51], v[134:135] op_sel:[0,0] op_sel_hi:[1,0]
    v_cvt_pk_bf16_f32 v184, v32, v33
    v_cvt_pk_bf16_f32 v185, v34, v35
    v_cvt_pk_bf16_f32 v186, v48, v49
    v_cvt_pk_bf16_f32 v187, v50, v51
    v_pk_max_i16 v184, v184, 0
    v_pk_max_i16 v185, v185, 0
    v_pk_max_i16 v186, v186, 0
    v_pk_max_i16 v187, v187, 0
    v_pk_fma_f32 v[36:37], v[148:149], v[132:133], v[36:37] op_sel:[0,1,0] op_sel_hi:[1,1,1]
    v_pk_fma_f32 v[38:39], v[150:151], v[132:133], v[38:39] op_sel:[0,1,0] op_sel_hi:[1,1,1]
    v_pk_fma_f32 v[52:53], v[148:149], v[134:135], v[52:53] op_sel:[0,1,0] op_sel_hi:[1,1,1]
    v_pk_fma_f32 v[54:55], v[150:151], v[134:135], v[54:55] op_sel:[0,1,0] op_sel_hi:[1,1,1]
    v_pk_mul_f32 v[36:37], v[36:37], v[132:133] op_sel:[0,0] op_sel_hi:[1,0]
    v_pk_mul_f32 v[38:39], v[38:39], v[132:133] op_sel:[0,0] op_sel_hi:[1,0]
    v_pk_mul_f32 v[52:53], v[52:53], v[134:135] op_sel:[0,0] op_sel_hi:[1,0]
    v_pk_mul_f32 v[54:55], v[54:55], v[134:135] op_sel:[0,0] op_sel_hi:[1,0]
    v_cvt_pk_bf16_f32 v188, v36, v37
    v_cvt_pk_bf16_f32 v189, v38, v39
    v_cvt_pk_bf16_f32 v190, v52, v53
    v_cvt_pk_bf16_f32 v191, v54, v55
    v_pk_max_i16 v188, v188, 0
    v_pk_max_i16 v189, v189, 0
    v_pk_max_i16 v190, v190, 0
    v_pk_max_i16 v191, v191, 0
    v_pk_fma_f32 v[40:41], v[152:153], v[132:133], v[40:41] op_sel:[0,1,0] op_sel_hi:[1,1,1]
    v_pk_fma_f32 v[42:43], v[154:155], v[132:133], v[42:43] op_sel:[0,1,0] op_sel_hi:[1,1,1]
    v_pk_fma_f32 v[56:57], v[152:153], v[134:135], v[56:57] op_sel:[0,1,0] op_sel_hi:[1,1,1]
    v_pk_fma_f32 v[58:59], v[154:155], v[134:135], v[58:59] op_sel:[0,1,0] op_sel_hi:[1,1,1]
    v_pk_mul_f32 v[40:41], v[40:41], v[132:133] op_sel:[0,0] op_sel_hi:[1,0]
    v_pk_mul_f32 v[42:43], v[42:43], v[132:133] op_sel:[0,0] op_sel_hi:[1,0]
    v_pk_mul_f32 v[56:57], v[56:57], v[134:135] op_sel:[0,0] op_sel_hi:[1,0]
    v_pk_mul_f32 v[58:59], v[58:59], v[134:135] op_sel:[0,0] op_sel_hi:[1,0]
    v_cvt_pk_bf16_f32 v192, v40, v41
    v_cvt_pk_bf16_f32 v193, v42, v43
    v_cvt_pk_bf16_f32 v194, v56, v57
    v_cvt_pk_bf16_f32 v195, v58, v59
    v_pk_max_i16 v192, v192, 0
    v_pk_max_i16 v193, v193, 0
    v_pk_max_i16 v194, v194, 0
    v_pk_max_i16 v195, v195, 0
    v_pk_fma_f32 v[44:45], v[156:157], v[132:133], v[44:45] op_sel:[0,1,0] op_sel_hi:[1,1,1]
    v_pk_fma_f32 v[46:47], v[158:159], v[132:133], v[46:47] op_sel:[0,1,0] op_sel_hi:[1,1,1]
    v_pk_fma_f32 v[60:61], v[156:157], v[134:135], v[60:61] op_sel:[0,1,0] op_sel_hi:[1,1,1]
    v_pk_fma_f32 v[62:63], v[158:159], v[134:135], v[62:63] op_sel:[0,1,0] op_sel_hi:[1,1,1]
    v_pk_mul_f32 v[44:45], v[44:45], v[132:133] op_sel:[0,0] op_sel_hi:[1,0]
    v_pk_mul_f32 v[46:47], v[46:47], v[132:133] op_sel:[0,0] op_sel_hi:[1,0]
    v_pk_mul_f32 v[60:61], v[60:61], v[134:135] op_sel:[0,0] op_sel_hi:[1,0]
    v_pk_mul_f32 v[62:63], v[62:63], v[134:135] op_sel:[0,0] op_sel_hi:[1,0]
    v_cvt_pk_bf16_f32 v196, v44, v45
    v_cvt_pk_bf16_f32 v197, v46, v47
    v_cvt_pk_bf16_f32 v198, v60, v61
    v_cvt_pk_bf16_f32 v199, v62, v63
    v_pk_max_i16 v196, v196, 0
    v_pk_max_i16 v197, v197, 0
    v_pk_max_i16 v198, v198, 0
    v_pk_max_i16 v199, v199, 0
L_epiH2:
    v_pk_fma_f32 v[64:65], v[144:145], v[136:137], v[64:65] op_sel:[0,1,0] op_sel_hi:[1,1,1]
    v_pk_fma_f32 v[66:67], v[146:147], v[136:137], v[66:67] op_sel:[0,1,0] op_sel_hi:[1,1,1]
    v_pk_fma_f32 v[80:81], v[144:145], v[138:139], v[80:81] op_sel:[0,1,0] op_sel_hi:[1,1,1]
    v_pk_fma_f32 v[82:83], v[146:147], v[138:139], v[82:83] op_sel:[0,1,0] op_sel_hi:[1,1,1]
    v_pk_mul_f32 v[64:65], v[64:65], v[136:137] op_sel:[0,0] op_sel_hi:[1,0]
    v_pk_mul_f32 v[66:67], v[66:67], v[136:137] op_sel:[0,0] op_sel_hi:[1,0]
    v_pk_mul_f32 v[80:81], v[80:81], v[138:139] op_sel:[0,0] op_sel_hi:[1,0]
    v_pk_mul_f32 v[82:83], v[82:83], v[138:139] op_sel:[0,0] op_sel_hi:[1,0]
    v_cvt_pk_bf16_f32 v200, v64, v65
    v_cvt_pk_bf16_f32 v201, v66, v67
    v_cvt_pk_bf16_f32 v202, v80, v81
    v_cvt_pk_bf16_f32 v203, v82, v83
    v_pk_max_i16 v200, v200, 0
    v_pk_max_i16 v201, v201, 0
    v_pk_max_i16 v202, v202, 0
    v_pk_max_i16 v203, v203, 0
    v_pk_fma_f32 v[68:69], v[148:149], v[136:137], v[68:69] op_sel:[0,1,0] op_sel_hi:[1,1,1]
    v_pk_fma_f32 v[70:71], v[150:151], v[136:137], v[70:71] op_sel:[0,1,0] op_sel_hi:[1,1,1]
    v_pk_fma_f32 v[84:85], v[148:149], v[138:139], v[84:85] op_sel:[0,1,0] op_sel_hi:[1,1,1]
    v_pk_fma_f32 v[86:87], v[150:151], v[138:139], v[86:87] op_sel:[0,1,0] op_sel_hi:[1,1,1]
    v_pk_mul_f32 v[68:69], v[68:69], v[136:137] op_sel:[0,0] op_sel_hi:[1,0]
    v_pk_mul_f32 v[70:71], v[70:71], v[136:137] op_sel:[0,0] op_sel_hi:[1,0]
    v_pk_mul_f32 v[84:85], v[84:85], v[138:139] op_sel:[0,0] op_sel_hi:[1,0]
    v_pk_mul_f32 v[86:87], v[86:87], v[138:139] op_sel:[0,0] op_sel_hi:[1,0]
    v_cvt_pk_bf16_f32 v204, v68, v69
    v_cvt_pk_bf16_f32 v205, v70, v71
    v_cvt_pk_bf16_f32 v206, v84, v85
    v_cvt_pk_bf16_f32 v207, v86, v87
    v_pk_max_i16 v204, v204, 0
    v_pk_max_i16 v205, v205, 0
    v_pk_max_i16 v206, v206, 0
    v_pk_max_i16 v207, v207, 0
    v_pk_fma_f32 v[72:73], v[152:153], v[136:137], v[72:73] op_sel:[0,1,0] op_sel_hi:[1,1,1]
    v_pk_fma_f32 v[74:75], v[154:155], v[136:137], v[74:75] op_sel:[0,1,0] op_sel_hi:[1,1,1]
    v_pk_fma_f32 v[88:89], v[152:153], v[138:139], v[88:89] op_sel:[0,1,0] op_sel_hi:[1,1,1]
    v_pk_fma_f32 v[90:91], v[154:155], v[138:139], v[90:91] op_sel:[0,1,0] op_sel_hi:[1,1,1]
    v_pk_mul_f32 v[72:73], v[72:73], v[136:137] op_sel:[0,0] op_sel_hi:[1,0]
    v_pk_mul_f32 v[74:75], v[74:75], v[136:137] op_sel:[0,0] op_sel_hi:[1,0]
    v_pk_mul_f32 v[88:89], v[88:89], v[138:139] op_sel:[0,0] op_sel_hi:[1,0]
    v_pk_mul_f32 v[90:91], v[90:91], v[138:139] op_sel:[0,0] op_sel_hi:[1,0]
    v_cvt_pk_bf16_f32 v208, v72, v73
    v_cvt_pk_bf16_f32 v209, v74, v75
    v_cvt_pk_bf16_f32 v210, v88, v89
    v_cvt_pk_bf16_f32 v211, v90, v91
    v_pk_max_i16 v208, v208, 0
    v_pk_max_i16 v209, v209, 0
    v_pk_max_i16 v210, v210, 0
    v_pk_max_i16 v211, v211, 0
    v_pk_fma_f32 v[76:77], v[156:157], v[136:137], v[76:77] op_sel:[0,1,0] op_sel_hi:[1,1,1]
    v_pk_fma_f32 v[78:79], v[158:159], v[136:137], v[78:79] op_sel:[0,1,0] op_sel_hi:[1,1,1]
    v_pk_fma_f32 v[92:93], v[156:157], v[138:139], v[92:93] op_sel:[0,1,0] op_sel_hi:[1,1,1]
    v_pk_fma_f32 v[94:95], v[158:159], v[138:139], v[94:95] op_sel:[0,1,0] op_sel_hi:[1,1,1]
    v_pk_mul_f32 v[76:77], v[76:77], v[136:137] op_sel:[0,0] op_sel_hi:[1,0]
    v_pk_mul_f32 v[78:79], v[78:79], v[136:137] op_sel:[0,0] op_sel_hi:[1,0]
    v_pk_mul_f32 v[92:93], v[92:93], v[138:139] op_sel:[0,0] op_sel_hi:[1,0]
    v_pk_mul_f32 v[94:95], v[94:95], v[138:139] op_sel:[0,0] op_sel_hi:[1,0]
    v_cvt_pk_bf16_f32 v212, v76, v77
    v_cvt_pk_bf16_f32 v213, v78, v79
    v_cvt_pk_bf16_f32 v214, v92, v93
    v_cvt_pk_bf16_f32 v215, v94, v95
    v_pk_max_i16 v212, v212, 0
    v_pk_max_i16 v213, v213, 0
    v_pk_max_i16 v214, v214, 0
    v_pk_max_i16 v215, v215, 0
L_epiH3:
    v_pk_fma_f32 v[96:97], v[144:145], v[140:141], v[96:97] op_sel:[0,1,0] op_sel_hi:[1,1,1]
    v_pk_fma_f32 v[98:99], v[146:147], v[140:141], v[98:99] op_sel:[0,1,0] op_sel_hi:[1,1,1]
    v_pk_fma_f32 v[112:113], v[144:145], v[142:143], v[112:113] op_sel:[0,1,0] op_sel_hi:[1,1,1]
    v_pk_fma_f32 v[114:115], v[146:147], v[142:143], v[114:115] op_sel:[0,1,0] op_sel_hi:[1,1,1]
    v_pk_mul_f32 v[96:97], v[96:97], v[140:141] op_sel:[0,0] op_sel_hi:[1,0]
    v_pk_mul_f32 v[98:99], v[98:99], v[140:141] op_sel:[0,0] op_sel_hi:[1,0]
    v_pk_mul_f32 v[112:113], v[112:113], v[142:143] op_sel:[0,0] op_sel_hi:[1,0]
    v_pk_mul_f32 v[114:115], v[114:115], v[142:143] op_sel:[0,0] op_sel_hi:[1,0]
    v_cvt_pk_bf16_f32 v216, v96, v97
    v_cvt_pk_bf16_f32 v217, v98, v99
    v_cvt_pk_bf16_f32 v218, v112, v113
    v_cvt_pk_bf16_f32 v219, v114, v115
    v_pk_max_i16 v216, v216, 0
    v_pk_max_i16 v217, v217, 0
    v_pk_max_i16 v218, v218, 0
    v_pk_max_i16 v219, v219, 0
    v_pk_fma_f32 v[100:101], v[148:149], v[140:141], v[100:101] op_sel:[0,1,0] op_sel_hi:[1,1,1]
    v_pk_fma_f32 v[102:103], v[150:151], v[140:141], v[102:103] op_sel:[0,1,0] op_sel_hi:[1,1,1]
    v_pk_fma_f32 v[116:117], v[148:149], v[142:143], v[116:117] op_sel:[0,1,0] op_sel_hi:[1,1,1]
    v_pk_fma_f32 v[118:119], v[150:151], v[142:143], v[118:119] op_sel:[0,1,0] op_sel_hi:[1,1,1]
    v_pk_mul_f32 v[100:101], v[100:101], v[140:141] op_sel:[0,0] op_sel_hi:[1,0]
    v_pk_mul_f32 v[102:103], v[102:103], v[140:141] op_sel:[0,0] op_sel_hi:[1,0]
    v_pk_mul_f32 v[116:117], v[116:117], v[142:143] op_sel:[0,0] op_sel_hi:[1,0]
    v_pk_mul_f32 v[118:119], v[118:119], v[142:143] op_sel:[0,0] op_sel_hi:[1,0]
    v_cvt_pk_bf16_f32 v220, v100, v101
    v_cvt_pk_bf16_f32 v221, v102, v103
    v_cvt_pk_bf16_f32 v222, v116, v117
    v_cvt_pk_bf16_f32 v223, v118, v119
    v_pk_max_i16 v220, v220, 0
    v_pk_max_i16 v221, v221, 0
    v_pk_max_i16 v222, v222, 0
    v_pk_max_i16 v223, v223, 0
    v_pk_fma_f32 v[104:105], v[152:153], v[140:141], v[104:105] op_sel:[0,1,0] op_sel_hi:[1,1,1]
    v_pk_fma_f32 v[106:107], v[154:155], v[140:141], v[106:107] op_sel:[0,1,0] op_sel_hi:[1,1,1]
    v_pk_fma_f32 v[120:121], v[152:153], v[142:143], v[120:121] op_sel:[0,1,0] op_sel_hi:[1,1,1]
    v_pk_fma_f32 v[122:123], v[154:155], v[142:143], v[122:123] op_sel:[0,1,0] op_sel_hi:[1,1,1]
    v_pk_mul_f32 v[104:105], v[104:105], v[140:141] op_sel:[0,0] op_sel_hi:[1,0]
    v_pk_mul_f32 v[106:107], v[106:107], v[140:141] op_sel:[0,0] op_sel_hi:[1,0]
    v_pk_mul_f32 v[120:121], v[120:121], v[142:143] op_sel:[0,0] op_sel_hi:[1,0]
    v_pk_mul_f32 v[122:123], v[122:123], v[142:143] op_sel:[0,0] op_sel_hi:[1,0]
    v_cvt_pk_bf16_f32 v224, v104, v105
    v_cvt_pk_bf16_f32 v225, v106, v107
    v_cvt_pk_bf16_f32 v226, v120, v121
    v_cvt_pk_bf16_f32 v227, v122, v123
    v_pk_max_i16 v224, v224, 0
    v_pk_max_i16 v225, v225, 0
    v_pk_max_i16 v226, v226, 0
    v_pk_max_i16 v227, v227, 0
    v_pk_fma_f32 v[108:109], v[156:157], v[140:141], v[108:109] op_sel:[0,1,0] op_sel_hi:[1,1,1]
    v_pk_fma_f32 v[110:111], v[158:159], v[140:141], v[110:111] op_sel:[0,1,0] op_sel_hi:[1,1,1]
    v_pk_fma_f32 v[124:125], v[156:157], v[142:143], v[124:125] op_sel:[0,1,0] op_sel_hi:[1,1,1]
    v_pk_fma_f32 v[126:127], v[158:159], v[142:143], v[126:127] op_sel:[0,1,0] op_sel_hi:[1,1,1]
    v_pk_mul_f32 v[108:109], v[108:109], v[140:141] op_sel:[0,0] op_sel_hi:[1,0]
    v_pk_mul_f32 v[110:111], v[110:111], v[140:141] op_sel:[0,0] op_sel_hi:[1,0]
    v_pk_mul_f32 v[124:125], v[124:125], v[142:143] op_sel:[0,0] op_sel_hi:[1,0]
    v_pk_mul_f32 v[126:127], v[126:127], v[142:143] op_sel:[0,0] op_sel_hi:[1,0]
    v_cvt_pk_bf16_f32 v228, v108, v109
    v_cvt_pk_bf16_f32 v229, v110, v111
    v_cvt_pk_bf16_f32 v230, v124, v125
    v_cvt_pk_bf16_f32 v231, v126, v127
    v_pk_max_i16 v228, v228, 0
    v_pk_max_i16 v229, v229, 0
    v_pk_max_i16 v230, v230, 0
    v_pk_max_i16 v231, v231, 0
    s_lshl_b32 s38, s32, 14
    s_add_u32 s38, s38, 49152
    v_lshl_add_u32 v128, v255, 4, s38
    ds_write_b128 v128, v[168:171] offset:0
    ds_write_b128 v128, v[172:175] offset:1024
    ds_write_b128 v128, v[176:179] offset:2048
    ds_write_b128 v128, v[180:183] offset:3072
    ds_write_b128 v128, v[184:187] offset:4096
    ds_write_b128 v128, v[188:191] offset:5120
    ds_write_b128 v128, v[192:195] offset:6144
    ds_write_b128 v128, v[196:199] offset:7168
    ds_write_b128 v128, v[200:203] offset:8192
    ds_write_b128 v128, v[204:207] offset:9216
    ds_write_b128 v128, v[208:211] offset:10240
    ds_write_b128 v128, v[212:215] offset:11264
    ds_write_b128 v128, v[216:219] offset:12288
    ds_write_b128 v128, v[220:223] offset:13312
    ds_write_b128 v128, v[224:227] offset:14336
    ds_write_b128 v128, v[228:231] offset:15360
    s_branch L_epi_done
L_epiV:
    s_barrier
L_epiV0:
    ds_read_b32 v192, v241 offset:0
    ds_read_b32 v193, v241 offset:64
    ds_read_b32 v194, v241 offset:128
    ds_read_b32 v195, v241 offset:192
    ds_read_b128 v[128:131], v240 offset:0
    ds_read_b128 v[160:163], v240 offset:1024
    ds_read_b128 v[132:135], v240 offset:64
    ds_read_b128 v[164:167], v240 offset:1088
    ds_read_b128 v[136:139], v240 offset:128
    ds_read_b128 v[168:171], v240 offset:1152
    ds_read_b128 v[140:143], v240 offset:192
    ds_read_b128 v[172:175], v240 offset:1216
    ds_read_b128 v[144:147], v240 offset:256
    ds_read_b128 v[176:179], v240 offset:1280
    ds_read_b128 v[148:151], v240 offset:320
    ds_read_b128 v[180:183], v240 offset:1344
    ds_read_b128 v[152:155], v240 offset:384
    ds_read_b128 v[184:187], v240 offset:1408
    ds_read_b128 v[156:159], v240 offset:448
    ds_read_b128 v[188:191], v240 offset:1472
    s_waitcnt lgkmcnt(12)
    v_pk_fma_f32 v[0:1], v[160:161], v[192:193], v[0:1] op_sel:[0,0,0] op_sel_hi:[1,0,1]
    v_pk_fma_f32 v[2:3], v[162:163], v[192:193], v[2:3] op_sel:[0,0,0] op_sel_hi:[1,0,1]
    v_pk_fma_f32 v[16:17], v[164:165], v[192:193], v[16:17] op_sel:[0,0,0] op_sel_hi:[1,0,1]
    v_pk_fma_f32 v[18:19], v[166:167], v[192:193], v[18:19] op_sel:[0,0,0] op_sel_hi:[1,0,1]
    v_pk_mul_f32 v[0:1], v[0:1], v[128:129]
    v_pk_mul_f32 v[2:3], v[2:3], v[130:131]
    v_pk_mul_f32 v[16:17], v[16:17], v[132:133]
    v_pk_mul_f32 v[18:19], v[18:19], v[134:135]
    v_cvt_pk_bf16_f32 v212, v0, v1
    v_cvt_pk_bf16_f32 v213, v2, v3
    v_cvt_pk_bf16_f32 v214, v16, v17
    v_cvt_pk_bf16_f32 v215, v18, v19
    buffer_store_dwordx4 v[212:215], v236, s[8:11], s55 offen sc1
    v_pk_fma_f32 v[4:5], v[160:161], v[192:193], v[4:5] op_sel:[0,1,0] op_sel_hi:[1,1,1]
    v_pk_fma_f32 v[6:7], v[162:163], v[192:193], v[6:7] op_sel:[0,1,0] op_sel_hi:[1,1,1]
    v_pk_fma_f32 v[20:21], v[164:165], v[192:193], v[20:21] op_sel:[0,1,0] op_sel_hi:[1,1,1]
    v_pk_fma_f32 v[22:23], v[166:167], v[192:193], v[22:23] op_sel:[0,1,0] op_sel_hi:[1,1,1]
    v_pk_mul_f32 v[4:5], v[4:5], v[128:129]
    v_pk_mul_f32 v[6:7], v[6:7], v[130:131]
    v_pk_mul_f32 v[20:21], v[20:21], v[132:133]
    v_pk_mul_f32 v[22:23], v[22:23], v[134:135]
    v_cvt_pk_bf16_f32 v216, v4, v5
    v_cvt_pk_bf16_f32 v217, v6, v7
    v_cvt_pk_bf16_f32 v218, v20, v21
    v_cvt_pk_bf16_f32 v219, v22, v23
    buffer_store_dwordx4 v[216:219], v237, s[8:11], s55 offen sc1
    v_pk_fma_f32 v[8:9], v[160:161], v[194:195], v[8:9] op_sel:[0,0,0] op_sel_hi:[1,0,1]
    v_pk_fma_f32 v[10:11], v[162:163], v[194:195], v[10:11] op_sel:[0,0,0] op_sel_hi:[1,0,1]
    v_pk_fma_f32 v[24:25], v[164:165], v[194:195], v[24:25] op_sel:[0,0,0] op_sel_hi:[1,0,1]
    v_pk_fma_f32 v[26:27], v[166:167], v[194:195], v[26:27] op_sel:[0,0,0] op_sel_hi:[1,0,1]
    v_pk_mul_f32 v[8:9], v[8:9], v[128:129]
    v_pk_mul_f32 v[10:11], v[10:11], v[130:131]
    v_pk_mul_f32 v[24:25], v[24:25], v[132:133]
    v_pk_mul_f32 v[26:27], v[26:27], v[134:135]
    v_cvt_pk_bf16_f32 v220, v8, v9
    v_cvt_pk_bf16_f32 v221, v10, v11
    v_cvt_pk_bf16_f32 v222, v24, v25
    v_cvt_pk_bf16_f32 v223, v26, v27
    buffer_store_dwordx4 v[220:223], v238, s[8:11], s55 offen sc1
    v_pk_fma_f32 v[12:13], v[160:161], v[194:195], v[12:13] op_sel:[0,1,0] op_sel_hi:[1,1,1]
    v_pk_fma_f32 v[14:15], v[162:163], v[194:195], v[14:15] op_sel:[0,1,0] op_sel_hi:[1,1,1]
    v_pk_fma_f32 v[28:29], v[164:165], v[194:195], v[28:29] op_sel:[0,1,0] op_sel_hi:[1,1,1]
    v_pk_fma_f32 v[30:31], v[166:167], v[194:195], v[30:31] op_sel:[0,1,0] op_sel_hi:[1,1,1]
    v_pk_mul_f32 v[12:13], v[12:13], v[128:129]
    v_pk_mul_f32 v[14:15], v[14:15], v[130:131]
    v_pk_mul_f32 v[28:29], v[28:29], v[132:133]
    v_pk_mul_f32 v[30:31], v[30:31], v[134:135]
    v_cvt_pk_bf16_f32 v224, v12, v13
    v_cvt_pk_bf16_f32 v225, v14, v15
    v_cvt_pk_bf16_f32 v226, v28, v29
    v_cvt_pk_bf16_f32 v227, v30, v31
    buffer_store_dwordx4 v[224:227], v239, s[8:11], s55 offen sc1
    s_add_u32 s55, s55, s54
L_epiV1:
    s_waitcnt lgkmcnt(8)
    v_pk_fma_f32 v[32:33], v[168:169], v[192:193], v[32:33] op_sel:[0,0,0] op_sel_hi:[1,0,1]
    v_pk_fma_f32 v[34:35], v[170:171], v[192:193], v[34:35] op_sel:[0,0,0] op_sel_hi:[1,0,1]
    v_pk_fma_f32 v[48:49], v[172:173], v[192:193], v[48:49] op_sel:[0,0,0] op_sel_hi:[1,0,1]
    v_pk_fma_f32 v[50:51], v[174:175], v[192:193], v[50:51] op_sel:[0,0,0] op_sel_hi:[1,0,1]
    v_pk_mul_f32 v[32:33], v[32:33], v[136:137]
    v_pk_mul_f32 v[34:35], v[34:35], v[138:139]
    v_pk_mul_f32 v[48:49], v[48:49], v[140:141]
    v_pk_mul_f32 v[50:51], v[50:51], v[142:143]
    v_cvt_pk_bf16_f32 v212, v32, v33
    v_cvt_pk_bf16_f32 v213, v34, v35
    v_cvt_pk_bf16_f32 v214, v48, v49
    v_cvt_pk_bf16_f32 v215, v50, v51
    buffer_store_dwordx4 v[212:215], v236, s[8:11], s55 offen sc1
    v_pk_fma_f32 v[36:37], v[168:169], v[192:193], v[36:37] op_sel:[0,1,0] op_sel_hi:[1,1,1]
    v_pk_fma_f32 v[38:39], v[170:171], v[192:193], v[38:39] op_sel:[0,1,0] op_sel_hi:[1,1,1]
    v_pk_fma_f32 v[52:53], v[172:173], v[192:193], v[52:53] op_sel:[0,1,0] op_sel_hi:[1,1,1]
    v_pk_fma_f32 v[54:55], v[174:175], v[192:193], v[54:55] op_sel:[0,1,0] op_sel_hi:[1,1,1]
    v_pk_mul_f32 v[36:37], v[36:37], v[136:137]
    v_pk_mul_f32 v[38:39], v[38:39], v[138:139]
    v_pk_mul_f32 v[52:53], v[52:53], v[140:141]
    v_pk_mul_f32 v[54:55], v[54:55], v[142:143]
    v_cvt_pk_bf16_f32 v216, v36, v37
    v_cvt_pk_bf16_f32 v217, v38, v39
    v_cvt_pk_bf16_f32 v218, v52, v53
    v_cvt_pk_bf16_f32 v219, v54, v55
    buffer_store_dwordx4 v[216:219], v237, s[8:11], s55 offen sc1
    v_pk_fma_f32 v[40:41], v[168:169], v[194:195], v[40:41] op_sel:[0,0,0] op_sel_hi:[1,0,1]
    v_pk_fma_f32 v[42:43], v[170:171], v[194:195], v[42:43] op_sel:[0,0,0] op_sel_hi:[1,0,1]
    v_pk_fma_f32 v[56:57], v[172:173], v[194:195], v[56:57] op_sel:[0,0,0] op_sel_hi:[1,0,1]
    v_pk_fma_f32 v[58:59], v[174:175], v[194:195], v[58:59] op_sel:[0,0,0] op_sel_hi:[1,0,1]
    v_pk_mul_f32 v[40:41], v[40:41], v[136:137]
    v_pk_mul_f32 v[42:43], v[42:43], v[138:139]
    v_pk_mul_f32 v[56:57], v[56:57], v[140:141]
    v_pk_mul_f32 v[58:59], v[58:59], v[142:143]
    v_cvt_pk_bf16_f32 v220, v40, v41
    v_cvt_pk_bf16_f32 v221, v42, v43
    v_cvt_pk_bf16_f32 v222, v56, v57
    v_cvt_pk_bf16_f32 v223, v58, v59
    buffer_store_dwordx4 v[220:223], v238, s[8:11], s55 offen sc1
    v_pk_fma_f32 v[44:45], v[168:169], v[194:195], v[44:45] op_sel:[0,1,0] op_sel_hi:[1,1,1]
    v_pk_fma_f32 v[46:47], v[170:171], v[194:195], v[46:47] op_sel:[0,1,0] op_sel_hi:[1,1,1]
    v_pk_fma_f32 v[60:61], v[172:173], v[194:195], v[60:61] op_sel:[0,1,0] op_sel_hi:[1,1,1]
    v_pk_fma_f32 v[62:63], v[174:175], v[194:195], v[62:63] op_sel:[0,1,0] op_sel_hi:[1,1,1]
    v_pk_mul_f32 v[44:45], v[44:45], v[136:137]
    v_pk_mul_f32 v[46:47], v[46:47], v[138:139]
    v_pk_mul_f32 v[60:61], v[60:61], v[140:141]
    v_pk_mul_f32 v[62:63], v[62:63], v[142:143]
    v_cvt_pk_bf16_f32 v224, v44, v45
    v_cvt_pk_bf16_f32 v225, v46, v47
    v_cvt_pk_bf16_f32 v226, v60, v61
    v_cvt_pk_bf16_f32 v227, v62, v63
    buffer_store_dwordx4 v[224:227], v239, s[8:11], s55 offen sc1
    s_add_u32 s55, s55, s54
L_epiV2:
    s_waitcnt lgkmcnt(4)
    v_pk_fma_f32 v[64:65], v[176:177], v[192:193], v[64:65] op_sel:[0,0,0] op_sel_hi:[1,0,1]
    v_pk_fma_f32 v[66:67], v[178:179], v[192:193], v[66:67] op_sel:[0,0,0] op_sel_hi:[1,0,1]
    v_pk_fma_f32 v[80:81], v[180:181], v[192:193], v[80:81] op_sel:[0,0,0] op_sel_hi:[1,0,1]
    v_pk_fma_f32 v[82:83], v[182:183], v[192:193], v[82:83] op_sel:[0,0,0] op_sel_hi:[1,0,1]
    v_pk_mul_f32 v[64:65], v[64:65], v[144:145]
    v_pk_mul_f32 v[66:67], v[66:67], v[146:147]
    v_pk_mul_f32 v[80:81], v[80:81], v[148:149]
    v_pk_mul_f32 v[82:83], v[82:83], v[150:151]
    v_cvt_pk_bf16_f32 v212, v64, v65
    v_cvt_pk_bf16_f32 v213, v66, v67
    v_cvt_pk_bf16_f32 v214, v80, v81
    v_cvt_pk_bf16_f32 v215, v82, v83
    buffer_store_dwordx4 v[212:215], v236, s[8:11], s55 offen sc1
    v_pk_fma_f32 v[68:69], v[176:177], v[192:193], v[68:69] op_sel:[0,1,0] op_sel_hi:[1,1,1]
    v_pk_fma_f32 v[70:71], v[178:179], v[192:193], v[70:71] op_sel:[0,1,0] op_sel_hi:[1,1,1]
    v_pk_fma_f32 v[84:85], v[180:181], v[192:193], v[84:85] op_sel:[0,1,0] op_sel_hi:[1,1,1]
    v_pk_fma_f32 v[86:87], v[182:183], v[192:193], v[86:87] op_sel:[0,1,0] op_sel_hi:[1,1,1]
    v_pk_mul_f32 v[68:69], v[68:69], v[144:145]
    v_pk_mul_f32 v[70:71], v[70:71], v[146:147]
    v_pk_mul_f32 v[84:85], v[84:85], v[148:149]
    v_pk_mul_f32 v[86:87], v[86:87], v[150:151]
    v_cvt_pk_bf16_f32 v216, v68, v69
    v_cvt_pk_bf16_f32 v217, v70, v71
    v_cvt_pk_bf16_f32 v218, v84, v85
    v_cvt_pk_bf16_f32 v219, v86, v87
    buffer_store_dwordx4 v[216:219], v237, s[8:11], s55 offen sc1
    v_pk_fma_f32 v[72:73], v[176:177], v[194:195], v[72:73] op_sel:[0,0,0] op_sel_hi:[1,0,1]
    v_pk_fma_f32 v[74:75], v[178:179], v[194:195], v[74:75] op_sel:[0,0,0] op_sel_hi:[1,0,1]
    v_pk_fma_f32 v[88:89], v[180:181], v[194:195], v[88:89] op_sel:[0,0,0] op_sel_hi:[1,0,1]
    v_pk_fma_f32 v[90:91], v[182:183], v[194:195], v[90:91] op_sel:[0,0,0] op_sel_hi:[1,0,1]
    v_pk_mul_f32 v[72:73], v[72:73], v[144:145]
    v_pk_mul_f32 v[74:75], v[74:75], v[146:147]
    v_pk_mul_f32 v[88:89], v[88:89], v[148:149]
    v_pk_mul_f32 v[90:91], v[90:91], v[150:151]
    v_cvt_pk_bf16_f32 v220, v72, v73
    v_cvt_pk_bf16_f32 v221, v74, v75
    v_cvt_pk_bf16_f32 v222, v88, v89
    v_cvt_pk_bf16_f32 v223, v90, v91
    buffer_store_dwordx4 v[220:223], v238, s[8:11], s55 offen sc1
    v_pk_fma_f32 v[76:77], v[176:177], v[194:195], v[76:77] op_sel:[0,1,0] op_sel_hi:[1,1,1]
    v_pk_fma_f32 v[78:79], v[178:179], v[194:195], v[78:79] op_sel:[0,1,0] op_sel_hi:[1,1,1]
    v_pk_fma_f32 v[92:93], v[180:181], v[194:195], v[92:93] op_sel:[0,1,0] op_sel_hi:[1,1,1]
    v_pk_fma_f32 v[94:95], v[182:183], v[194:195], v[94:95] op_sel:[0,1,0] op_sel_hi:[1,1,1]
    v_pk_mul_f32 v[76:77], v[76:77], v[144:145]
    v_pk_mul_f32 v[78:79], v[78:79], v[146:147]
    v_pk_mul_f32 v[92:93], v[92:93], v[148:149]
    v_pk_mul_f32 v[94:95], v[94:95], v[150:151]
    v_cvt_pk_bf16_f32 v224, v76, v77
    v_cvt_pk_bf16_f32 v225, v78, v79
    v_cvt_pk_bf16_f32 v226, v92, v93
    v_cvt_pk_bf16_f32 v227, v94, v95
    buffer_store_dwordx4 v[224:227], v239, s[8:11], s55 offen sc1
    s_add_u32 s55, s55, s54
L_epiV3:
    s_waitcnt lgkmcnt(0)
    v_pk_fma_f32 v[96:97], v[184:185], v[192:193], v[96:97] op_sel:[0,0,0] op_sel_hi:[1,0,1]
    v_pk_fma_f32 v[98:99], v[186:187], v[192:193], v[98:99] op_sel:[0,0,0] op_sel_hi:[1,0,1]
    v_pk_fma_f32 v[112:113], v[188:189], v[192:193], v[112:113] op_sel:[0,0,0] op_sel_hi:[1,0,1]
    v_pk_fma_f32 v[114:115], v[190:191], v[192:193], v[114:115] op_sel:[0,0,0] op_sel_hi:[1,0,1]
    v_pk_mul_f32 v[96:97], v[96:97], v[152:153]
    v_pk_mul_f32 v[98:99], v[98:99], v[154:155]
    v_pk_mul_f32 v[112:113], v[112:113], v[156:157]
    v_pk_mul_f32 v[114:115], v[114:115], v[158:159]
    v_cvt_pk_bf16_f32 v212, v96, v97
    v_cvt_pk_bf16_f32 v213, v98, v99
    v_cvt_pk_bf16_f32 v214, v112, v113
    v_cvt_pk_bf16_f32 v215, v114, v115
    buffer_store_dwordx4 v[212:215], v236, s[8:11], s55 offen sc1
    v_pk_fma_f32 v[100:101], v[184:185], v[192:193], v[100:101] op_sel:[0,1,0] op_sel_hi:[1,1,1]
    v_pk_fma_f32 v[102:103], v[186:187], v[192:193], v[102:103] op_sel:[0,1,0] op_sel_hi:[1,1,1]
    v_pk_fma_f32 v[116:117], v[188:189], v[192:193], v[116:117] op_sel:[0,1,0] op_sel_hi:[1,1,1]
    v_pk_fma_f32 v[118:119], v[190:191], v[192:193], v[118:119] op_sel:[0,1,0] op_sel_hi:[1,1,1]
    v_pk_mul_f32 v[100:101], v[100:101], v[152:153]
    v_pk_mul_f32 v[102:103], v[102:103], v[154:155]
    v_pk_mul_f32 v[116:117], v[116:117], v[156:157]
    v_pk_mul_f32 v[118:119], v[118:119], v[158:159]
    v_cvt_pk_bf16_f32 v216, v100, v101
    v_cvt_pk_bf16_f32 v217, v102, v103
    v_cvt_pk_bf16_f32 v218, v116, v117
    v_cvt_pk_bf16_f32 v219, v118, v119
    buffer_store_dwordx4 v[216:219], v237, s[8:11], s55 offen sc1
    v_pk_fma_f32 v[104:105], v[184:185], v[194:195], v[104:105] op_sel:[0,0,0] op_sel_hi:[1,0,1]
    v_pk_fma_f32 v[106:107], v[186:187], v[194:195], v[106:107] op_sel:[0,0,0] op_sel_hi:[1,0,1]
    v_pk_fma_f32 v[120:121], v[188:189], v[194:195], v[120:121] op_sel:[0,0,0] op_sel_hi:[1,0,1]
    v_pk_fma_f32 v[122:123], v[190:191], v[194:195], v[122:123] op_sel:[0,0,0] op_sel_hi:[1,0,1]
    v_pk_mul_f32 v[104:105], v[104:105], v[152:153]
    v_pk_mul_f32 v[106:107], v[106:107], v[154:155]
    v_pk_mul_f32 v[120:121], v[120:121], v[156:157]
    v_pk_mul_f32 v[122:123], v[122:123], v[158:159]
    v_cvt_pk_bf16_f32 v220, v104, v105
    v_cvt_pk_bf16_f32 v221, v106, v107
    v_cvt_pk_bf16_f32 v222, v120, v121
    v_cvt_pk_bf16_f32 v223, v122, v123
    buffer_store_dwordx4 v[220:223], v238, s[8:11], s55 offen sc1
    v_pk_fma_f32 v[108:109], v[184:185], v[194:195], v[108:109] op_sel:[0,1,0] op_sel_hi:[1,1,1]
    v_pk_fma_f32 v[110:111], v[186:187], v[194:195], v[110:111] op_sel:[0,1,0] op_sel_hi:[1,1,1]
    v_pk_fma_f32 v[124:125], v[188:189], v[194:195], v[124:125] op_sel:[0,1,0] op_sel_hi:[1,1,1]
    v_pk_fma_f32 v[126:127], v[190:191], v[194:195], v[126:127] op_sel:[0,1,0] op_sel_hi:[1,1,1]
    v_pk_mul_f32 v[108:109], v[108:109], v[152:153]
    v_pk_mul_f32 v[110:111], v[110:111], v[154:155]
    v_pk_mul_f32 v[124:125], v[124:125], v[156:157]
    v_pk_mul_f32 v[126:127], v[126:127], v[158:159]
    v_cvt_pk_bf16_f32 v224, v108, v109
    v_cvt_pk_bf16_f32 v225, v110, v111
    v_cvt_pk_bf16_f32 v226, v124, v125
    v_cvt_pk_bf16_f32 v227, v126, v127
    buffer_store_dwordx4 v[224:227], v239, s[8:11], s55 offen sc1
L_epi_done:
    s_setprio 1
    s_add_u32 s24, s42, 17612800
    s_addc_u32 s25, s43, 0
    s_mov_b32 s26, 185856
    s_mov_b32 s27, 0x20000
    s_mov_b32 s12, s42
    s_mov_b32 s13, s43
    s_mov_b32 s14, 2629632
    s_mov_b32 s15, 0x20000
    s_add_u32 s16, s42, 2629632
    s_addc_u32 s17, s43, 0
    s_mov_b32 s18, 5251072
    s_mov_b32 s19, 0x20000
    s_add_u32 s20, s42, 14974976
    s_addc_u32 s21, s43, 0
    s_mov_b32 s22, 2637824
    s_mov_b32 s23, 0x20000
    s_lshr_b32 s38, s37, 3
    s_lshl_b32 s44, s36, 2
    s_add_u32 s44, s44, s38
    s_mul_i32 s49, s44, 164096
    s_and_b32 s45, s37, 7
    s_lshl_b32 s45, s45, 3
    s_lshl_b32 s38, s32, 1
    s_add_u32 s45, s45, s38
    v_and_b32 v146, 31, v255
    v_lshrrev_b32 v147, 5, v255
    v_subrev_u32 v148, 16, v146
    v_lshrrev_b32 v149, 2, v148
    v_mul_u32_u24 v149, 20, v149
    v_add3_u32 v149, v149, v148, 36
    v_cmp_gt_u32 vcc, 16, v146
    v_and_b32 v150, 3, v146
    v_cmp_eq_u32 s[50:51], 0, v150
    v_cndmask_b32 v149, v149, v146, vcc
    v_add_u32 v149, 80, v149
    v_mul_u32_u24 v150, 192, v147
    v_add_u32 v149, v149, v150
    s_mul_i32 s38, s32, 12288
    v_lshl_add_u32 v149, v149, 4, s38
    v_mov_b32 v150, 1065369472
    v_mov_b32 v151, 0x3f80
    v_cndmask_b32 v153, 0, v150, s[50:51]
    v_cndmask_b32 v152, v153, v150, vcc
    v_cndmask_b32 v153, v153, v151, vcc
    v_mov_b32 v154, v152
    v_mov_b32 v155, v153
    ds_write_b128 v149, v[152:155]
    ds_write_b128 v149, v[152:155] offset:6144
    s_mov_b32 s46, 0
    v_and_b32 v148, 7, v146
    v_lshlrev_b32 v148, 1, v148
    v_and_b32 v149, 16, v146
    v_bfe_u32 v150, v146, 3, 1
    v_add3_u32 v148, v148, v149, v150
    v_lshlrev_b32 v148, 3, v148
    v_lshl_add_u32 v144, v147, 8, v148
    v_min_u32 v150, 21, v146
    v_mul_u32_u24 v149, 384, v147
    v_lshl_add_u32 v149, v150, 4, v149
    v_add_u32 v145, 1536, v149
    v_lshlrev_b32 v156, 3, v255
    v_lshlrev_b32 v148, 3, v146
    v_lshl_add_u32 v157, v147, 30, v148
    s_lshl_b32 s38, s34, 3
    s_add_u32 s38, s38, s33
    s_lshl_b32 s38, s38, 7
    s_add_u32 s38, s38, 120320
    v_mov_b32 v159, s38
    v_mov_b32 v160, 1
    v_mov_b32 v64, 0
    v_mov_b32 v65, 0
    v_mov_b32 v66, 0
    v_mov_b32 v67, 0
    v_mov_b32 v68, 0
    v_mov_b32 v69, 0
    v_mov_b32 v70, 0
    v_mov_b32 v71, 0
    v_mov_b32 v72, 0
    v_mov_b32 v73, 0
    v_mov_b32 v74, 0
    v_mov_b32 v75, 0
    v_mov_b32 v76, 0
    v_mov_b32 v77, 0
    v_mov_b32 v78, 0
    v_mov_b32 v79, 0
    v_mov_b32 v80, 0
    v_mov_b32 v81, 0
    v_mov_b32 v82, 0
    v_mov_b32 v83, 0
    v_mov_b32 v84, 0
    v_mov_b32 v85, 0
    v_mov_b32 v86, 0
    v_mov_b32 v87, 0
    v_mov_b32 v88, 0
    v_mov_b32 v89, 0
    v_mov_b32 v90, 0
    v_mov_b32 v91, 0
    v_mov_b32 v92, 0
    v_mov_b32 v93, 0
    v_mov_b32 v94, 0
    v_mov_b32 v95, 0
    v_mov_b32 v132, 0
    v_mov_b32 v133, 0
    v_mov_b32 v134, 0
    v_mov_b32 v135, 0
    v_mov_b32 v108, 0
    v_mov_b32 v109, 0
    s_mov_b32 s51, 0xffff
    s_mov_b32 s48, 0
    s_mov_b32 s47, 24576
    s_mul_i32 s38, s44, 82176
    s_mul_i32 s39, s45, 1280
    s_add_u32 s39, s39, s38
    s_cmp_eq_u32 s35, 3
    v_mov_b32 v161, 162308
    s_cselect_b32 s52, 99, 3
    s_cbranch_scc1 L_a_nodrain
    s_waitcnt vmcnt(0)
L_a_nodrain:
    s_mov_b64 exec, 1
    ds_add_rtn_u32 v161, v161, v160
    s_waitcnt lgkmcnt(0)
    v_readfirstlane_b32 s50, v161
    s_cmp_lg_u32 s50, s52
    s_cbranch_scc1 L_a_noflag
    buffer_store_dword v160, v159, s[24:27], 0 offen sc1
L_a_noflag:
    s_mov_b64 exec, -1
    s_waitcnt lgkmcnt(0)
    s_mul_i32 s28, s45, 41216
    s_mul_i32 s29, s44, 1280
    s_add_u32 s28, s28, s29
    s_add_u32 s29, s28, 41216
    v_lshlrev_b32 v164, 4, v255
    v_lshrrev_b32 v165, 5, v255
    v_lshlrev_b32 v165, 30, v165
    v_lshl_add_u32 v165, v255, 3, v165
    s_and_b32 s52, s37, 7
    s_lshl_b32 s52, s52, 2
    s_lshr_b32 s50, s36, 1
    s_add_u32 s52, s52, s50
    s_mul_i32 s52, s52, 81920
    s_and_b32 s50, s36, 1
    s_lshl_b32 s50, s50, 2
    s_lshr_b32 s53, s37, 3
    s_add_u32 s50, s50, s53
    s_mul_i32 s50, s50, 160
    s_add_u32 s52, s52, s50
    v_add_u32 v146, 0, v255
    v_mul_u32_u24 v147, 3277, v146
    v_lshrrev_b32 v147, 16, v147
    v_mul_u32_u24 v148, 20, v147
    v_sub_u32 v146, v146, v148
    v_lshl_add_u32 v147, s32, 4, v147
    v_mul_u32_u24 v148, 336, v147
    v_lshl_add_u32 v148, v146, 4, v148
    v_add_u32 v245, 49152, v148
    v_and_b32 v148, 1, v147
    v_lshlrev_b32 v148, 4, v148
    v_bfe_u32 v149, v147, 1, 4
    v_and_b32 v147, 32, v147
    v_add3_u32 v147, v147, v148, v149
    v_mul_u32_u24 v147, 1280, v147
    v_lshl_add_u32 v240, v146, 3, v147
    v_add_u32 v146, 64, v255
    v_mul_u32_u24 v147, 3277, v146
    v_lshrrev_b32 v147, 16, v147
    v_mul_u32_u24 v148, 20, v147
    v_sub_u32 v146, v146, v148
    v_lshl_add_u32 v147, s32, 4, v147
    v_mul_u32_u24 v148, 336, v147
    v_lshl_add_u32 v148, v146, 4, v148
    v_add_u32 v246, 49152, v148
    v_and_b32 v148, 1, v147
    v_lshlrev_b32 v148, 4, v148
    v_bfe_u32 v149, v147, 1, 4
    v_and_b32 v147, 32, v147
    v_add3_u32 v147, v147, v148, v149
    v_mul_u32_u24 v147, 1280, v147
    v_lshl_add_u32 v241, v146, 3, v147
    v_add_u32 v146, 128, v255
    v_mul_u32_u24 v147, 3277, v146
    v_lshrrev_b32 v147, 16, v147
    v_mul_u32_u24 v148, 20, v147
    v_sub_u32 v146, v146, v148
    v_lshl_add_u32 v147, s32, 4, v147
    v_mul_u32_u24 v148, 336, v147
    v_lshl_add_u32 v148, v146, 4, v148
    v_add_u32 v247, 49152, v148
    v_and_b32 v148, 1, v147
    v_lshlrev_b32 v148, 4, v148
    v_bfe_u32 v149, v147, 1, 4
    v_and_b32 v147, 32, v147
    v_add3_u32 v147, v147, v148, v149
    v_mul_u32_u24 v147, 1280, v147
    v_lshl_add_u32 v242, v146, 3, v147
    s_barrier
    buffer_load_dwordx2 v[112:113], v156, s[12:15], s39 offen offset:0
    buffer_load_dwordx2 v[114:115], v156, s[12:15], s39 offen offset:512
    buffer_load_dwordx2 v[116:117], v157, s[12:15], s39 offen offset:1024
    buffer_load_dwordx2 v[118:119], v156, s[12:15], s39 offen offset:1280
    buffer_load_dwordx2 v[120:121], v156, s[12:15], s39 offen offset:1792
    buffer_load_dwordx2 v[122:123], v157, s[12:15], s39 offen offset:2304
    s_waitcnt vmcnt(0)
    s_barrier
    ds_read2st64_b64 v[158:161], v144 offset0:0 offset1:1
    ds_read2st64_b64 v[136:139], v144 offset0:2 offset1:8
    ds_read2st64_b64 v[124:127], v144 offset0:6 offset1:7
    ds_read_b128 v[128:131], v145 offset:0
    s_mov_b32 s8, s4
    s_mov_b32 s9, s5
    s_mov_b32 s10, 2621440
    s_mov_b32 s11, 0x20000
    buffer_load_dwordx2 v[168:169], v240, s[8:11], s52 offen
    buffer_load_dwordx2 v[170:171], v241, s[8:11], s52 offen
    buffer_load_dwordx2 v[172:173], v242, s[8:11], s52 offen
    s_waitcnt lgkmcnt(2)
    v_mfma_f32_32x32x16_bf16 v[0:15], v[158:161], v[112:115], 0
    v_mfma_f32_32x32x16_bf16 v[32:47], v[158:161], v[118:121], 0
    v_mfma_f32_32x32x8_bf16 v[0:15], v[136:137], v[116:117], v[0:15]
    v_mfma_f32_32x32x8_bf16 v[32:47], v[136:137], v[122:123], v[32:47]
    s_waitcnt lgkmcnt(1)
    v_mfma_f32_32x32x16_bf16 v[16:31], v[124:127], v[112:115], 0
    v_mfma_f32_32x32x16_bf16 v[48:63], v[124:127], v[118:121], 0
    v_mfma_f32_32x32x8_bf16 v[16:31], v[138:139], v[116:117], v[16:31]
    v_mfma_f32_32x32x8_bf16 v[48:63], v[138:139], v[122:123], v[48:63]
    s_nop 6
    v_max3_f32 v154, v0, v1, v2
    v_max_f32 v154, v154, v3
    v_max3_f32 v154, v154, v4, v5
    v_max3_f32 v154, v154, v6, v7
    v_max3_f32 v154, v154, v8, v9
    v_max3_f32 v154, v154, v10, v11
    v_max3_f32 v154, v154, v12, v13
    v_max3_f32 v154, v154, v14, v15
    v_max3_f32 v155, v32, v33, v34
    v_max_f32 v155, v155, v35
    v_max3_f32 v155, v155, v36, v37
    v_max3_f32 v155, v155, v38, v39
    v_max3_f32 v155, v155, v40, v41
    v_max3_f32 v155, v155, v42, v43
    v_max3_f32 v155, v155, v44, v45
    v_max3_f32 v155, v155, v46, v47
    v_max3_f32 v154, v154, v16, v17
    v_max3_f32 v154, v154, v18, v19
    v_max3_f32 v154, v154, v20, v21
    v_max3_f32 v154, v154, v22, v23
    v_max3_f32 v154, v154, v24, v25
    v_max3_f32 v154, v154, v26, v27
    v_max3_f32 v154, v154, v28, v29
    v_max3_f32 v154, v154, v30, v31
    v_max3_f32 v155, v155, v48, v49
    v_max3_f32 v155, v155, v50, v51
    v_max3_f32 v155, v155, v52, v53
    v_max3_f32 v155, v155, v54, v55
    v_max3_f32 v155, v155, v56, v57
    v_max3_f32 v155, v155, v58, v59
    v_max3_f32 v155, v155, v60, v61
    v_max3_f32 v155, v155, v62, v63
    v_mov_b32 v60, 0
    v_mov_b32 v61, 0
    v_mov_b32 v62, 0
    v_mov_b32 v63, 0
    v_mov_b32 v146, v154
    v_mov_b32 v147, v155
    s_mov_b32 s50, 3267887104
    v_cmp_lt_u32 vcc, 31, v255
    v_permlane32_swap_b32 v146, v154
    v_permlane32_swap_b32 v147, v155
    s_nop 0
    v_max_f32 v154, v154, v146
    v_max_f32 v155, v155, v147
    v_sub_f32 v152, s50, v154
    v_sub_f32 v153, s50, v155
    v_cvt_pk_bf16_f32 v146, v152, v152
    v_and_b32 v147, 0xffff0000, v146
    v_sub_f32 v154, v152, v147
    v_cvt_pk_bf16_f32 v147, v154, v154
    v_and_b32 v148, 0xffff0000, v147
    v_sub_f32 v154, v154, v148
    v_cvt_pk_bf16_f32 v154, v154, 0
    v_and_or_b32 v146, v146, s51, v148
    v_cndmask_b32 v116, v116, v146, vcc
    v_cndmask_b32 v117, v117, v154, vcc
    v_cvt_pk_bf16_f32 v149, v153, v153
    v_and_b32 v150, 0xffff0000, v149
    v_sub_f32 v155, v153, v150
    v_cvt_pk_bf16_f32 v150, v155, v155
    v_and_b32 v151, 0xffff0000, v150
    v_sub_f32 v155, v155, v151
    v_cvt_pk_bf16_f32 v155, v155, 0
    v_and_or_b32 v149, v149, s51, v151
    v_cndmask_b32 v122, v122, v149, vcc
    v_cndmask_b32 v123, v123, v155, vcc
    v_add_f32 v0, v152, v0
    v_add_f32 v1, v152, v1
    v_add_f32 v2, v152, v2
    v_add_f32 v3, v152, v3
    v_add_f32 v4, v152, v4
    v_add_f32 v5, v152, v5
    v_add_f32 v6, v152, v6
    v_add_f32 v7, v152, v7
    v_add_f32 v8, v152, v8
    v_add_f32 v9, v152, v9
    v_add_f32 v10, v152, v10
    v_add_f32 v11, v152, v11
    v_add_f32 v12, v152, v12
    v_add_f32 v13, v152, v13
    v_add_f32 v14, v152, v14
    v_add_f32 v15, v152, v15
    v_add_f32 v32, v153, v32
    v_add_f32 v33, v153, v33
    v_add_f32 v34, v153, v34
    v_add_f32 v35, v153, v35
    v_add_f32 v36, v153, v36
    v_add_f32 v37, v153, v37
    v_add_f32 v38, v153, v38
    v_add_f32 v39, v153, v39
    v_add_f32 v40, v153, v40
    v_add_f32 v41, v153, v41
    v_add_f32 v42, v153, v42
    v_add_f32 v43, v153, v43
    v_add_f32 v44, v153, v44
    v_add_f32 v45, v153, v45
    v_add_f32 v46, v153, v46
    v_add_f32 v47, v153, v47
.p2align 6
L_aloop:
    v_exp_f32 v0, v0
    v_exp_f32 v1, v1
    v_exp_f32 v2, v2
    v_exp_f32 v3, v3
    v_mfma_f32_32x32x16_bf16 v[16:31], v[124:127], v[112:115], 0
    v_cvt_pk_bf16_f32 v110, v60, v61
    v_cvt_pk_bf16_f32 v111, v62, v63
    v_exp_f32 v4, v4
    v_exp_f32 v5, v5
    v_exp_f32 v6, v6
    v_exp_f32 v7, v7
    v_mfma_f32_32x32x16_bf16 v[80:95], v[132:135], v[108:111], v[80:95]
    ds_read_b128 v[132:135], v145 offset:768
    v_cvt_pk_bf16_f32 v96, v0, v1
    v_cvt_pk_bf16_f32 v97, v2, v3
    v_exp_f32 v8, v8
    v_exp_f32 v9, v9
    v_exp_f32 v10, v10
    v_exp_f32 v11, v11
    v_mfma_f32_32x32x8_bf16 v[16:31], v[138:139], v[116:117], v[16:31]
    s_waitcnt lgkmcnt(1)
    v_cvt_pk_bf16_f32 v98, v4, v5
    v_cvt_pk_bf16_f32 v99, v6, v7
    v_exp_f32 v12, v12
    v_exp_f32 v13, v13
    v_exp_f32 v14, v14
    v_exp_f32 v15, v15
    v_mfma_f32_32x32x16_bf16 v[64:79], v[128:131], v[96:99], v[64:79]
    ds_read2st64_b64 v[140:143], v144 offset0:14 offset1:20
    v_cvt_pk_bf16_f32 v100, v8, v9
    v_cvt_pk_bf16_f32 v101, v10, v11
    v_exp_f32 v32, v32
    v_exp_f32 v33, v33
    v_exp_f32 v34, v34
    v_exp_f32 v35, v35
    v_mfma_f32_32x32x16_bf16 v[48:63], v[124:127], v[118:121], 0
    s_waitcnt lgkmcnt(1)
    ds_read2st64_b64 v[124:127], v144 offset0:12 offset1:13
    v_cvt_pk_bf16_f32 v102, v12, v13
    v_cvt_pk_bf16_f32 v103, v14, v15
    v_exp_f32 v36, v36
    v_exp_f32 v37, v37
    v_exp_f32 v38, v38
    v_exp_f32 v39, v39
    v_mfma_f32_32x32x16_bf16 v[64:79], v[132:135], v[100:103], v[64:79]
    v_cvt_pk_bf16_f32 v104, v32, v33
    v_cvt_pk_bf16_f32 v105, v34, v35
    v_exp_f32 v40, v40
    v_exp_f32 v41, v41
    v_exp_f32 v42, v42
    v_exp_f32 v43, v43
    v_mfma_f32_32x32x8_bf16 v[48:63], v[138:139], v[122:123], v[48:63]
    v_cvt_pk_bf16_f32 v106, v36, v37
    v_cvt_pk_bf16_f32 v107, v38, v39
    v_exp_f32 v44, v44
    v_exp_f32 v45, v45
    v_exp_f32 v46, v46
    v_exp_f32 v47, v47
    v_mfma_f32_32x32x16_bf16 v[80:95], v[128:131], v[104:107], v[80:95]
    s_waitcnt lgkmcnt(0)
    ds_read_b128 v[128:131], v145 offset:3072
    v_cvt_pk_bf16_f32 v108, v40, v41
    v_cvt_pk_bf16_f32 v109, v42, v43
    v_exp_f32 v16, v16
    v_exp_f32 v17, v17
    v_exp_f32 v18, v18
    v_exp_f32 v19, v19
    v_mfma_f32_32x32x16_bf16 v[0:15], v[124:127], v[112:115], 0
    v_cvt_pk_bf16_f32 v110, v44, v45
    v_cvt_pk_bf16_f32 v111, v46, v47
    v_exp_f32 v20, v20
    v_exp_f32 v21, v21
    v_exp_f32 v22, v22
    v_exp_f32 v23, v23
    v_mfma_f32_32x32x16_bf16 v[80:95], v[132:135], v[108:111], v[80:95]
    ds_read_b128 v[132:135], v145 offset:3840
    v_cvt_pk_bf16_f32 v96, v16, v17
    v_cvt_pk_bf16_f32 v97, v18, v19
    v_exp_f32 v24, v24
    v_exp_f32 v25, v25
    v_exp_f32 v26, v26
    v_exp_f32 v27, v27
    v_mfma_f32_32x32x8_bf16 v[0:15], v[140:141], v[116:117], v[0:15]
    s_waitcnt lgkmcnt(1)
    v_cvt_pk_bf16_f32 v98, v20, v21
    v_cvt_pk_bf16_f32 v99, v22, v23
    v_exp_f32 v28, v28
    v_exp_f32 v29, v29
    v_exp_f32 v30, v30
    v_exp_f32 v31, v31
    v_mfma_f32_32x32x16_bf16 v[64:79], v[128:131], v[96:99], v[64:79]
    v_cvt_pk_bf16_f32 v100, v24, v25
    v_cvt_pk_bf16_f32 v101, v26, v27
    v_exp_f32 v48, v48
    v_exp_f32 v49, v49
    v_exp_f32 v50, v50
    v_exp_f32 v51, v51
    v_mfma_f32_32x32x16_bf16 v[32:47], v[124:127], v[118:121], 0
    s_waitcnt lgkmcnt(0)
    ds_read2st64_b64 v[124:127], v144 offset0:18 offset1:19
    v_cvt_pk_bf16_f32 v102, v28, v29
    v_cvt_pk_bf16_f32 v103, v30, v31
    v_exp_f32 v52, v52
    v_exp_f32 v53, v53
    v_exp_f32 v54, v54
    v_exp_f32 v55, v55
    v_mfma_f32_32x32x16_bf16 v[64:79], v[132:135], v[100:103], v[64:79]
    s_barrier
    v_cvt_pk_bf16_f32 v104, v48, v49
    v_cvt_pk_bf16_f32 v105, v50, v51
    v_exp_f32 v56, v56
    v_exp_f32 v57, v57
    v_exp_f32 v58, v58
    v_exp_f32 v59, v59
    v_mfma_f32_32x32x8_bf16 v[32:47], v[140:141], v[122:123], v[32:47]
    v_cvt_pk_bf16_f32 v106, v52, v53
    v_cvt_pk_bf16_f32 v107, v54, v55
    v_exp_f32 v60, v60
    v_exp_f32 v61, v61
    v_exp_f32 v62, v62
    v_exp_f32 v63, v63
    v_mfma_f32_32x32x16_bf16 v[80:95], v[128:131], v[104:107], v[80:95]
    s_waitcnt lgkmcnt(0)
    ds_read_b128 v[128:131], v145 offset:6144
    v_cvt_pk_bf16_f32 v108, v56, v57
    v_cvt_pk_bf16_f32 v109, v58, v59
    v_exp_f32 v0, v0
    v_exp_f32 v1, v1
    v_exp_f32 v2, v2
    v_exp_f32 v3, v3
    v_mfma_f32_32x32x16_bf16 v[16:31], v[124:127], v[112:115], 0
    v_cvt_pk_bf16_f32 v110, v60, v61
    v_cvt_pk_bf16_f32 v111, v62, v63
    v_exp_f32 v4, v4
    v_exp_f32 v5, v5
    v_exp_f32 v6, v6
    v_exp_f32 v7, v7
    v_mfma_f32_32x32x16_bf16 v[80:95], v[132:135], v[108:111], v[80:95]
    ds_read_b128 v[132:135], v145 offset:6912
    v_cvt_pk_bf16_f32 v96, v0, v1
    v_cvt_pk_bf16_f32 v97, v2, v3
    v_exp_f32 v8, v8
    v_exp_f32 v9, v9
    v_exp_f32 v10, v10
    v_exp_f32 v11, v11
    v_mfma_f32_32x32x8_bf16 v[16:31], v[142:143], v[116:117], v[16:31]
    s_waitcnt lgkmcnt(1)
    v_cvt_pk_bf16_f32 v98, v4, v5
    v_cvt_pk_bf16_f32 v99, v6, v7
    v_exp_f32 v12, v12
    v_exp_f32 v13, v13
    v_exp_f32 v14, v14
    v_exp_f32 v15, v15
    v_mfma_f32_32x32x16_bf16 v[64:79], v[128:131], v[96:99], v[64:79]
    ds_read2st64_b64 v[136:139], v144 offset0:26 offset1:32
    v_cvt_pk_bf16_f32 v100, v8, v9
    v_cvt_pk_bf16_f32 v101, v10, v11
    v_exp_f32 v32, v32
    v_exp_f32 v33, v33
    v_exp_f32 v34, v34
    v_exp_f32 v35, v35
    v_mfma_f32_32x32x16_bf16 v[48:63], v[124:127], v[118:121], 0
    s_waitcnt lgkmcnt(1)
    ds_read2st64_b64 v[124:127], v144 offset0:24 offset1:25
    v_cvt_pk_bf16_f32 v102, v12, v13
    v_cvt_pk_bf16_f32 v103, v14, v15
    v_exp_f32 v36, v36
    v_exp_f32 v37, v37
    v_exp_f32 v38, v38
    v_exp_f32 v39, v39
    v_mfma_f32_32x32x16_bf16 v[64:79], v[132:135], v[100:103], v[64:79]
    v_cvt_pk_bf16_f32 v104, v32, v33
    v_cvt_pk_bf16_f32 v105, v34, v35
    v_exp_f32 v40, v40
    v_exp_f32 v41, v41
    v_exp_f32 v42, v42
    v_exp_f32 v43, v43
    v_mfma_f32_32x32x8_bf16 v[48:63], v[142:143], v[122:123], v[48:63]
    v_cvt_pk_bf16_f32 v106, v36, v37
    v_cvt_pk_bf16_f32 v107, v38, v39
    v_exp_f32 v44, v44
    v_exp_f32 v45, v45
    v_exp_f32 v46, v46
    v_exp_f32 v47, v47
    v_mfma_f32_32x32x16_bf16 v[80:95], v[128:131], v[104:107], v[80:95]
    s_waitcnt lgkmcnt(0)
    ds_read_b128 v[128:131], v145 offset:9216
    v_cvt_pk_bf16_f32 v108, v40, v41
    v_cvt_pk_bf16_f32 v109, v42, v43
    v_exp_f32 v16, v16
    v_exp_f32 v17, v17
    v_exp_f32 v18, v18
    v_exp_f32 v19, v19
    v_mfma_f32_32x32x16_bf16 v[0:15], v[124:127], v[112:115], 0
    v_cvt_pk_bf16_f32 v110, v44, v45
    v_cvt_pk_bf16_f32 v111, v46, v47
    v_exp_f32 v20, v20
    v_exp_f32 v21, v21
    v_exp_f32 v22, v22
    v_exp_f32 v23, v23
    v_mfma_f32_32x32x16_bf16 v[80:95], v[132:135], v[108:111], v[80:95]
    ds_read_b128 v[132:135], v145 offset:9984
    v_cvt_pk_bf16_f32 v96, v16, v17
    v_cvt_pk_bf16_f32 v97, v18, v19
    v_exp_f32 v24, v24
    v_exp_f32 v25, v25
    v_exp_f32 v26, v26
    v_exp_f32 v27, v27
    v_mfma_f32_32x32x8_bf16 v[0:15], v[136:137], v[116:117], v[0:15]
    s_waitcnt lgkmcnt(1)
    v_cvt_pk_bf16_f32 v98, v20, v21
    v_cvt_pk_bf16_f32 v99, v22, v23
    v_exp_f32 v28, v28
    v_exp_f32 v29, v29
    v_exp_f32 v30, v30
    v_exp_f32 v31, v31
    v_mfma_f32_32x32x16_bf16 v[64:79], v[128:131], v[96:99], v[64:79]
    v_cvt_pk_bf16_f32 v100, v24, v25
    v_cvt_pk_bf16_f32 v101, v26, v27
    v_exp_f32 v48, v48
    v_exp_f32 v49, v49
    v_exp_f32 v50, v50
    v_exp_f32 v51, v51
    v_mfma_f32_32x32x16_bf16 v[32:47], v[124:127], v[118:121], 0
    s_waitcnt lgkmcnt(0)
    ds_read2st64_b64 v[124:127], v144 offset0:30 offset1:31
    v_cvt_pk_bf16_f32 v102, v28, v29
    v_cvt_pk_bf16_f32 v103, v30, v31
    v_exp_f32 v52, v52
    v_exp_f32 v53, v53
    v_exp_f32 v54, v54
    v_exp_f32 v55, v55
    v_mfma_f32_32x32x16_bf16 v[64:79], v[132:135], v[100:103], v[64:79]
    v_cvt_pk_bf16_f32 v104, v48, v49
    v_cvt_pk_bf16_f32 v105, v50, v51
    v_exp_f32 v56, v56
    v_exp_f32 v57, v57
    v_exp_f32 v58, v58
    v_exp_f32 v59, v59
    v_mfma_f32_32x32x8_bf16 v[32:47], v[136:137], v[122:123], v[32:47]
    v_cvt_pk_bf16_f32 v106, v52, v53
    v_cvt_pk_bf16_f32 v107, v54, v55
    v_exp_f32 v60, v60
    v_exp_f32 v61, v61
    v_exp_f32 v62, v62
    v_exp_f32 v63, v63
    v_mfma_f32_32x32x16_bf16 v[80:95], v[128:131], v[104:107], v[80:95]
    s_waitcnt lgkmcnt(0)
    ds_read_b128 v[128:131], v145 offset:12288
    v_cvt_pk_bf16_f32 v108, v56, v57
    v_cvt_pk_bf16_f32 v109, v58, v59
    v_exp_f32 v0, v0
    v_exp_f32 v1, v1
    v_exp_f32 v2, v2
    v_exp_f32 v3, v3
    v_mfma_f32_32x32x16_bf16 v[16:31], v[124:127], v[112:115], 0
    v_cvt_pk_bf16_f32 v110, v60, v61
    v_cvt_pk_bf16_f32 v111, v62, v63
    v_exp_f32 v4, v4
    v_exp_f32 v5, v5
    v_exp_f32 v6, v6
    v_exp_f32 v7, v7
    v_mfma_f32_32x32x16_bf16 v[80:95], v[132:135], v[108:111], v[80:95]
    ds_read_b128 v[132:135], v145 offset:13056
    v_cvt_pk_bf16_f32 v96, v0, v1
    v_cvt_pk_bf16_f32 v97, v2, v3
    v_exp_f32 v8, v8
    v_exp_f32 v9, v9
    v_exp_f32 v10, v10
    v_exp_f32 v11, v11
    v_mfma_f32_32x32x8_bf16 v[16:31], v[138:139], v[116:117], v[16:31]
    s_waitcnt lgkmcnt(1)
    v_cvt_pk_bf16_f32 v98, v4, v5
    v_cvt_pk_bf16_f32 v99, v6, v7
    v_exp_f32 v12, v12
    v_exp_f32 v13, v13
    v_exp_f32 v14, v14
    v_exp_f32 v15, v15
    v_mfma_f32_32x32x16_bf16 v[64:79], v[128:131], v[96:99], v[64:79]
    ds_read2st64_b64 v[140:143], v144 offset0:38 offset1:44
    v_cvt_pk_bf16_f32 v100, v8, v9
    v_cvt_pk_bf16_f32 v101, v10, v11
    v_exp_f32 v32, v32
    v_exp_f32 v33, v33
    v_exp_f32 v34, v34
    v_exp_f32 v35, v35
    v_mfma_f32_32x32x16_bf16 v[48:63], v[124:127], v[118:121], 0
    s_waitcnt lgkmcnt(1)
    ds_read2st64_b64 v[124:127], v144 offset0:36 offset1:37
    v_cvt_pk_bf16_f32 v102, v12, v13
    v_cvt_pk_bf16_f32 v103, v14, v15
    v_exp_f32 v36, v36
    v_exp_f32 v37, v37
    v_exp_f32 v38, v38
    v_exp_f32 v39, v39
    v_mfma_f32_32x32x16_bf16 v[64:79], v[132:135], v[100:103], v[64:79]
    v_cvt_pk_bf16_f32 v104, v32, v33
    v_cvt_pk_bf16_f32 v105, v34, v35
    v_exp_f32 v40, v40
    v_exp_f32 v41, v41
    v_exp_f32 v42, v42
    v_exp_f32 v43, v43
    v_mfma_f32_32x32x8_bf16 v[48:63], v[138:139], v[122:123], v[48:63]
    v_cvt_pk_bf16_f32 v106, v36, v37
    v_cvt_pk_bf16_f32 v107, v38, v39
    v_exp_f32 v44, v44
    v_exp_f32 v45, v45
    v_exp_f32 v46, v46
    v_exp_f32 v47, v47
    v_mfma_f32_32x32x16_bf16 v[80:95], v[128:131], v[104:107], v[80:95]
    s_waitcnt lgkmcnt(0)
    ds_read_b128 v[128:131], v145 offset:15360
    v_cvt_pk_bf16_f32 v108, v40, v41
    v_cvt_pk_bf16_f32 v109, v42, v43
    v_exp_f32 v16, v16
    v_exp_f32 v17, v17
    v_exp_f32 v18, v18
    v_exp_f32 v19, v19
    v_mfma_f32_32x32x16_bf16 v[0:15], v[124:127], v[112:115], 0
    v_cvt_pk_bf16_f32 v110, v44, v45
    v_cvt_pk_bf16_f32 v111, v46, v47
    v_exp_f32 v20, v20
    v_exp_f32 v21, v21
    v_exp_f32 v22, v22
    v_exp_f32 v23, v23
    v_mfma_f32_32x32x16_bf16 v[80:95], v[132:135], v[108:111], v[80:95]
    ds_read_b128 v[132:135], v145 offset:16128
    v_cvt_pk_bf16_f32 v96, v16, v17
    v_cvt_pk_bf16_f32 v97, v18, v19
    v_exp_f32 v24, v24
    v_exp_f32 v25, v25
    v_exp_f32 v26, v26
    v_exp_f32 v27, v27
    v_mfma_f32_32x32x8_bf16 v[0:15], v[140:141], v[116:117], v[0:15]
    s_waitcnt lgkmcnt(1)
    v_cvt_pk_bf16_f32 v98, v20, v21
    v_cvt_pk_bf16_f32 v99, v22, v23
    v_exp_f32 v28, v28
    v_exp_f32 v29, v29
    v_exp_f32 v30, v30
    v_exp_f32 v31, v31
    v_mfma_f32_32x32x16_bf16 v[64:79], v[128:131], v[96:99], v[64:79]
    v_cvt_pk_bf16_f32 v100, v24, v25
    v_cvt_pk_bf16_f32 v101, v26, v27
    v_exp_f32 v48, v48
    v_exp_f32 v49, v49
    v_exp_f32 v50, v50
    v_exp_f32 v51, v51
    v_mfma_f32_32x32x16_bf16 v[32:47], v[124:127], v[118:121], 0
    s_waitcnt lgkmcnt(0)
    ds_read2st64_b64 v[124:127], v144 offset0:42 offset1:43
    v_cvt_pk_bf16_f32 v102, v28, v29
    v_cvt_pk_bf16_f32 v103, v30, v31
    v_exp_f32 v52, v52
    v_exp_f32 v53, v53
    v_exp_f32 v54, v54
    v_exp_f32 v55, v55
    v_mfma_f32_32x32x16_bf16 v[64:79], v[132:135], v[100:103], v[64:79]
    s_barrier
    v_cvt_pk_bf16_f32 v104, v48, v49
    v_cvt_pk_bf16_f32 v105, v50, v51
    v_exp_f32 v56, v56
    v_exp_f32 v57, v57
    v_exp_f32 v58, v58
    v_exp_f32 v59, v59
    v_mfma_f32_32x32x8_bf16 v[32:47], v[140:141], v[122:123], v[32:47]
    v_cvt_pk_bf16_f32 v106, v52, v53
    v_cvt_pk_bf16_f32 v107, v54, v55
    v_exp_f32 v60, v60
    v_exp_f32 v61, v61
    v_exp_f32 v62, v62
    v_exp_f32 v63, v63
    v_mfma_f32_32x32x16_bf16 v[80:95], v[128:131], v[104:107], v[80:95]
    s_waitcnt lgkmcnt(0)
    ds_read_b128 v[128:131], v145 offset:18432
    v_cvt_pk_bf16_f32 v108, v56, v57
    v_cvt_pk_bf16_f32 v109, v58, v59
    v_exp_f32 v0, v0
    v_exp_f32 v1, v1
    v_exp_f32 v2, v2
    v_exp_f32 v3, v3
    v_mfma_f32_32x32x16_bf16 v[16:31], v[124:127], v[112:115], 0
    v_add_u32 v144, s47, v144
    v_cvt_pk_bf16_f32 v110, v60, v61
    v_cvt_pk_bf16_f32 v111, v62, v63
    v_exp_f32 v4, v4
    v_exp_f32 v5, v5
    v_exp_f32 v6, v6
    v_exp_f32 v7, v7
    v_mfma_f32_32x32x16_bf16 v[80:95], v[132:135], v[108:111], v[80:95]
    ds_read_b128 v[132:135], v145 offset:19200
    v_cvt_pk_bf16_f32 v96, v0, v1
    v_cvt_pk_bf16_f32 v97, v2, v3
    v_exp_f32 v8, v8
    v_exp_f32 v9, v9
    v_exp_f32 v10, v10
    v_exp_f32 v11, v11
    v_mfma_f32_32x32x8_bf16 v[16:31], v[142:143], v[116:117], v[16:31]
    s_waitcnt lgkmcnt(1)
    v_cvt_pk_bf16_f32 v98, v4, v5
    v_cvt_pk_bf16_f32 v99, v6, v7
    v_exp_f32 v12, v12
    v_exp_f32 v13, v13
    v_exp_f32 v14, v14
    v_exp_f32 v15, v15
    v_mfma_f32_32x32x16_bf16 v[64:79], v[128:131], v[96:99], v[64:79]
    ds_read2st64_b64 v[136:139], v144 offset0:2 offset1:8
    v_cvt_pk_bf16_f32 v100, v8, v9
    v_cvt_pk_bf16_f32 v101, v10, v11
    v_exp_f32 v32, v32
    v_exp_f32 v33, v33
    v_exp_f32 v34, v34
    v_exp_f32 v35, v35
    v_mfma_f32_32x32x16_bf16 v[48:63], v[124:127], v[118:121], 0
    s_waitcnt lgkmcnt(1)
    ds_read2st64_b64 v[124:127], v144 offset0:0 offset1:1
    v_cvt_pk_bf16_f32 v102, v12, v13
    v_cvt_pk_bf16_f32 v103, v14, v15
    v_exp_f32 v36, v36
    v_exp_f32 v37, v37
    v_exp_f32 v38, v38
    v_exp_f32 v39, v39
    v_mfma_f32_32x32x16_bf16 v[64:79], v[132:135], v[100:103], v[64:79]
    v_cvt_pk_bf16_f32 v104, v32, v33
    v_cvt_pk_bf16_f32 v105, v34, v35
    v_exp_f32 v40, v40
    v_exp_f32 v41, v41
    v_exp_f32 v42, v42
    v_exp_f32 v43, v43
    v_mfma_f32_32x32x8_bf16 v[48:63], v[142:143], v[122:123], v[48:63]
    v_cvt_pk_bf16_f32 v106, v36, v37
    v_cvt_pk_bf16_f32 v107, v38, v39
    v_exp_f32 v44, v44
    v_exp_f32 v45, v45
    v_exp_f32 v46, v46
    v_exp_f32 v47, v47
    v_mfma_f32_32x32x16_bf16 v[80:95], v[128:131], v[104:107], v[80:95]
    s_waitcnt lgkmcnt(0)
    ds_read_b128 v[128:131], v145 offset:21504
    v_cvt_pk_bf16_f32 v108, v40, v41
    v_cvt_pk_bf16_f32 v109, v42, v43
    v_exp_f32 v16, v16
    v_exp_f32 v17, v17
    v_exp_f32 v18, v18
    v_exp_f32 v19, v19
    v_mfma_f32_32x32x16_bf16 v[0:15], v[124:127], v[112:115], 0
    s_add_u32 s48, s48, 1
    v_cvt_pk_bf16_f32 v110, v44, v45
    v_cvt_pk_bf16_f32 v111, v46, v47
    v_exp_f32 v20, v20
    v_exp_f32 v21, v21
    v_exp_f32 v22, v22
    v_exp_f32 v23, v23
    v_mfma_f32_32x32x16_bf16 v[80:95], v[132:135], v[108:111], v[80:95]
    ds_read_b128 v[132:135], v145 offset:22272
    v_cvt_pk_bf16_f32 v96, v16, v17
    v_cvt_pk_bf16_f32 v97, v18, v19
    v_exp_f32 v24, v24
    v_exp_f32 v25, v25
    v_exp_f32 v26, v26
    v_exp_f32 v27, v27
    v_mfma_f32_32x32x8_bf16 v[0:15], v[136:137], v[116:117], v[0:15]
    s_waitcnt lgkmcnt(1)
    v_cvt_pk_bf16_f32 v98, v20, v21
    v_cvt_pk_bf16_f32 v99, v22, v23
    v_exp_f32 v28, v28
    v_exp_f32 v29, v29
    v_exp_f32 v30, v30
    v_exp_f32 v31, v31
    v_mfma_f32_32x32x16_bf16 v[64:79], v[128:131], v[96:99], v[64:79]
    v_add_u32 v145, s47, v145
    v_cvt_pk_bf16_f32 v100, v24, v25
    v_cvt_pk_bf16_f32 v101, v26, v27
    v_exp_f32 v48, v48
    v_exp_f32 v49, v49
    v_exp_f32 v50, v50
    v_exp_f32 v51, v51
    v_mfma_f32_32x32x16_bf16 v[32:47], v[124:127], v[118:121], 0
    s_waitcnt lgkmcnt(0)
    ds_read2st64_b64 v[124:127], v144 offset0:6 offset1:7
    v_cvt_pk_bf16_f32 v102, v28, v29
    v_cvt_pk_bf16_f32 v103, v30, v31
    v_exp_f32 v52, v52
    v_exp_f32 v53, v53
    v_exp_f32 v54, v54
    v_exp_f32 v55, v55
    v_mfma_f32_32x32x16_bf16 v[64:79], v[132:135], v[100:103], v[64:79]
    s_sub_u32 s47, 0, s47
    v_cvt_pk_bf16_f32 v104, v48, v49
    v_cvt_pk_bf16_f32 v105, v50, v51
    v_exp_f32 v56, v56
    v_exp_f32 v57, v57
    v_exp_f32 v58, v58
    v_exp_f32 v59, v59
    v_mfma_f32_32x32x8_bf16 v[32:47], v[136:137], v[122:123], v[32:47]
    s_cmp_lt_u32 s48, 8
    v_cvt_pk_bf16_f32 v106, v52, v53
    v_cvt_pk_bf16_f32 v107, v54, v55
    v_exp_f32 v60, v60
    v_exp_f32 v61, v61
    v_exp_f32 v62, v62
    v_exp_f32 v63, v63
    v_mfma_f32_32x32x16_bf16 v[80:95], v[128:131], v[104:107], v[80:95]
    s_waitcnt lgkmcnt(0)
    ds_read_b128 v[128:131], v145 offset:0
    v_cvt_pk_bf16_f32 v108, v56, v57
    v_cvt_pk_bf16_f32 v109, v58, v59
    s_cbranch_scc1 L_aloop
    v_cvt_pk_bf16_f32 v110, v60, v61
    v_cvt_pk_bf16_f32 v111, v62, v63
    v_mov_b32 v148, 0
    v_mov_b32 v149, 0
    v_mfma_f32_32x32x16_bf16 v[80:95], v[132:135], v[108:111], v[80:95]
L_merge:
    v_mov_b32 v146, v72
    v_mov_b32 v147, v72
    s_mov_b32 s53, 2071986176
    s_nop 0
    v_permlane32_swap_b32 v146, v147
    s_nop 0
    v_rcp_f32 v146, v147
    v_cmp_ngt_f32 s[54:55], s53, v147
    v_pk_mul_f32 v[64:65], v[64:65], v[146:147] op_sel_hi:[1,0]
    v_pk_mul_f32 v[66:67], v[66:67], v[146:147] op_sel_hi:[1,0]
    v_pk_mul_f32 v[68:69], v[68:69], v[146:147] op_sel_hi:[1,0]
    v_pk_mul_f32 v[70:71], v[70:71], v[146:147] op_sel_hi:[1,0]
    v_pk_mul_f32 v[72:73], v[72:73], v[146:147] op_sel_hi:[1,0]
    v_pk_mul_f32 v[74:75], v[74:75], v[146:147] op_sel_hi:[1,0]
    v_pk_fma_f32 v[148:149], v[64:65], 0, v[148:149] op_sel_hi:[1,0,1]
    v_pk_fma_f32 v[148:149], v[66:67], 0, v[148:149] op_sel_hi:[1,0,1]
    v_pk_fma_f32 v[148:149], v[68:69], 0, v[148:149] op_sel_hi:[1,0,1]
    v_pk_fma_f32 v[148:149], v[70:71], 0, v[148:149] op_sel_hi:[1,0,1]
    v_pk_fma_f32 v[148:149], v[72:73], 0, v[148:149] op_sel_hi:[1,0,1]
    v_pk_fma_f32 v[148:149], v[74:75], 0, v[148:149] op_sel_hi:[1,0,1]
    v_cvt_pk_bf16_f32 v96, v64, v65
    v_cvt_pk_bf16_f32 v97, v66, v67
    v_cvt_pk_bf16_f32 v98, v68, v69
    v_cvt_pk_bf16_f32 v99, v70, v71
    v_cvt_pk_bf16_f32 v100, v72, v73
    v_cvt_pk_bf16_f32 v101, v74, v75
    v_mov_b32 v150, v88
    v_mov_b32 v151, v88
    s_cmp_lg_u32 s46, 0
    s_cselect_b64 s[50:51], 0, -1
    v_permlane32_swap_b32 v150, v151
    s_nop 0
    v_rcp_f32 v150, v151
    v_cmp_ngt_f32 vcc, s53, v151
    s_or_b64 s[54:55], s[54:55], vcc
    v_pk_mul_f32 v[80:81], v[80:81], v[150:151] op_sel_hi:[1,0]
    v_pk_mul_f32 v[82:83], v[82:83], v[150:151] op_sel_hi:[1,0]
    v_pk_mul_f32 v[84:85], v[84:85], v[150:151] op_sel_hi:[1,0]
    v_pk_mul_f32 v[86:87], v[86:87], v[150:151] op_sel_hi:[1,0]
    v_pk_mul_f32 v[88:89], v[88:89], v[150:151] op_sel_hi:[1,0]
    v_pk_mul_f32 v[90:91], v[90:91], v[150:151] op_sel_hi:[1,0]
    v_pk_fma_f32 v[148:149], v[80:81], 0, v[148:149] op_sel_hi:[1,0,1]
    v_pk_fma_f32 v[148:149], v[82:83], 0, v[148:149] op_sel_hi:[1,0,1]
    v_pk_fma_f32 v[148:149], v[84:85], 0, v[148:149] op_sel_hi:[1,0,1]
    v_pk_fma_f32 v[148:149], v[86:87], 0, v[148:149] op_sel_hi:[1,0,1]
    v_pk_fma_f32 v[148:149], v[88:89], 0, v[148:149] op_sel_hi:[1,0,1]
    v_pk_fma_f32 v[148:149], v[90:91], 0, v[148:149] op_sel_hi:[1,0,1]
    v_cvt_pk_bf16_f32 v104, v80, v81
    v_cvt_pk_bf16_f32 v105, v82, v83
    v_cvt_pk_bf16_f32 v106, v84, v85
    v_cvt_pk_bf16_f32 v107, v86, v87
    v_cvt_pk_bf16_f32 v108, v88, v89
    v_cvt_pk_bf16_f32 v109, v90, v91
    v_cmp_u_f32 vcc, v148, v149
    s_or_b64 vcc, vcc, s[54:55]
    s_and_b64 vcc, vcc, s[50:51]
    s_cbranch_scc1 L_fallback
    buffer_store_dwordx4 v[96:99], v164, s[20:23], s28 offen sc1
    buffer_store_dwordx2 v[100:101], v165, s[20:23], s28 offen offset:1024 sc1
    buffer_store_dwordx4 v[104:107], v164, s[20:23], s29 offen sc1
    buffer_store_dwordx2 v[108:109], v165, s[20:23], s29 offen offset:1024 sc1
    v_mov_b32 v147, 1
    v_mov_b32 v148, 162304
    s_mov_b64 exec, 1
    ds_add_u32 v148, v147
    s_mov_b64 exec, -1
    s_setprio 2
    s_waitcnt vmcnt(4)
    s_mov_b32 s12, s60
    s_mov_b32 s13, s61
    s_mov_b32 s14, 0
    s_mov_b32 s15, 0x20000
    s_mov_b32 s38, s52
    v_add_u32 v115, 55296, v245
    v_add_u32 v116, 55296, v246
    v_add_u32 v117, 55296, v247
    v_lshlrev_b32 v80, 16, v168
    v_and_b32 v81, 0xffff0000, v168
    v_lshlrev_b32 v82, 16, v169
    v_and_b32 v83, 0xffff0000, v169
    v_lshlrev_b32 v84, 16, v170
    v_and_b32 v85, 0xffff0000, v170
    v_lshlrev_b32 v86, 16, v171
    v_and_b32 v87, 0xffff0000, v171
    v_lshlrev_b32 v88, 16, v172
    v_and_b32 v89, 0xffff0000, v172
    v_lshlrev_b32 v90, 16, v173
    v_and_b32 v91, 0xffff0000, v173
L_final:
    ds_read_b128 v[0:3], v245
    ds_read_b128 v[4:7], v245 offset:27648
    ds_read_b128 v[8:11], v115
    ds_read_b128 v[12:15], v115 offset:27648
    ds_read_b128 v[16:19], v246
    ds_read_b128 v[20:23], v246 offset:27648
    ds_read_b128 v[24:27], v116
    ds_read_b128 v[28:31], v116 offset:27648
    ds_read_b128 v[32:35], v247
    ds_read_b128 v[36:39], v247 offset:27648
    ds_read_b128 v[40:43], v117
    ds_read_b128 v[44:47], v117 offset:27648
    s_waitcnt lgkmcnt(8)
    v_pk_add_f32 v[0:1], v[0:1], v[4:5]
    v_pk_add_f32 v[2:3], v[2:3], v[6:7]
    v_pk_add_f32 v[8:9], v[8:9], v[12:13]
    v_pk_add_f32 v[10:11], v[10:11], v[14:15]
    v_pk_add_f32 v[0:1], v[0:1], v[80:81]
    v_pk_add_f32 v[2:3], v[2:3], v[82:83]
    v_pk_add_f32 v[0:1], v[0:1], v[8:9]
    v_pk_add_f32 v[2:3], v[2:3], v[10:11]
    v_cvt_pk_bf16_f32 v4, v0, v1
    v_cvt_pk_bf16_f32 v5, v2, v3
    buffer_store_dwordx2 v[4:5], v240, s[12:15], s38 offen
    s_waitcnt lgkmcnt(4)
    v_pk_add_f32 v[16:17], v[16:17], v[20:21]
    v_pk_add_f32 v[18:19], v[18:19], v[22:23]
    v_pk_add_f32 v[24:25], v[24:25], v[28:29]
    v_pk_add_f32 v[26:27], v[26:27], v[30:31]
    v_pk_add_f32 v[16:17], v[16:17], v[84:85]
    v_pk_add_f32 v[18:19], v[18:19], v[86:87]
    v_pk_add_f32 v[16:17], v[16:17], v[24:25]
    v_pk_add_f32 v[18:19], v[18:19], v[26:27]
    v_cvt_pk_bf16_f32 v20, v16, v17
    v_cvt_pk_bf16_f32 v21, v18, v19
    buffer_store_dwordx2 v[20:21], v241, s[12:15], s38 offen
    s_waitcnt lgkmcnt(0)
    v_pk_add_f32 v[32:33], v[32:33], v[36:37]
    v_pk_add_f32 v[34:35], v[34:35], v[38:39]
    v_pk_add_f32 v[40:41], v[40:41], v[44:45]
    v_pk_add_f32 v[42:43], v[42:43], v[46:47]
    v_pk_add_f32 v[32:33], v[32:33], v[88:89]
    v_pk_add_f32 v[34:35], v[34:35], v[90:91]
    v_pk_add_f32 v[32:33], v[32:33], v[40:41]
    v_pk_add_f32 v[34:35], v[34:35], v[42:43]
    v_cvt_pk_bf16_f32 v36, v32, v33
    v_cvt_pk_bf16_f32 v37, v34, v35
    buffer_store_dwordx2 v[36:37], v242, s[12:15], s38 offen
    s_cmp_lg_u32 s14, 0
    s_cbranch_scc1 L_fin
    s_mov_b32 s14, 2621440
    s_barrier
    s_branch L_final
    s_branch L_fin
L_idle:
    s_barrier
    s_barrier
    s_barrier
    s_barrier
    s_barrier
    s_barrier
    s_barrier
    s_barrier
    s_barrier
    s_barrier
    s_barrier
    s_branch L_epi_done
L_stats:
    s_mul_i32 s44, s36, 3
    s_add_u32 s44, s44, s37
    s_and_b32 s45, s44, 3
    s_lshl_b32 s44, s44, 3
    s_add_u32 s44, s44, s32
    v_lshrrev_b32 v2, 4, v255
    v_lshl_add_u32 v2, s44, 2, v2
    v_and_b32 v3, 15, v255
    v_lshlrev_b32 v4, 3, v2
    v_mul_u32_u24 v2, 1280, v2
    v_lshl_add_u32 v2, v3, 4, v2
    s_mov_b32 s10, 2621440
    s_mov_b32 s11, 0x20000
    s_mov_b32 s51, 983040
    s_mov_b32 s52, 1966080
    s_waitcnt lgkmcnt(0)
    s_mov_b32 s8, s4
    s_mov_b32 s9, s5
    buffer_load_dwordx4 v[8:11], v2, s[8:11], 0 offen offset:0
    buffer_load_dwordx4 v[12:15], v2, s[8:11], 0 offen offset:256
    buffer_load_dwordx4 v[16:19], v2, s[8:11], 0 offen offset:512
    buffer_load_dwordx4 v[20:23], v2, s[8:11], 0 offen offset:768
    buffer_load_dwordx4 v[24:27], v2, s[8:11], 0 offen offset:1024
    buffer_load_dwordx4 v[28:31], v2, s[8:11], s51 offen offset:0
    buffer_load_dwordx4 v[32:35], v2, s[8:11], s51 offen offset:256
    buffer_load_dwordx4 v[36:39], v2, s[8:11], s51 offen offset:512
    buffer_load_dwordx4 v[40:43], v2, s[8:11], s51 offen offset:768
    buffer_load_dwordx4 v[44:47], v2, s[8:11], s51 offen offset:1024
    buffer_load_dwordx4 v[48:51], v2, s[8:11], s52 offen offset:0
    buffer_load_dwordx4 v[52:55], v2, s[8:11], s52 offen offset:256
    buffer_load_dwordx4 v[56:59], v2, s[8:11], s52 offen offset:512
    buffer_load_dwordx4 v[60:63], v2, s[8:11], s52 offen offset:768
    buffer_load_dwordx4 v[64:67], v2, s[8:11], s52 offen offset:1024
    s_mul_i32 s46, s44, 171
    s_lshr_b32 s46, s46, 9
    s_mul_i32 s47, s46, 3
    s_sub_u32 s47, s44, s47
    s_cmp_lt_u32 s46, 30
    s_movk_i32 s48, 3456
    s_cselect_b32 s48, 3840, s48
    s_cselect_b32 s49, 0, 30
    s_sub_u32 s49, s46, s49
    s_lshl_b32 s49, s49, 7
    s_mul_i32 s50, s47, 216
    v_lshrrev_b32 v5, 3, v255
    v_add_u32 v5, s50, v5
    v_mul_u32_u24 v5, s48, v5
    v_and_b32 v6, 7, v255
    v_lshl_add_u32 v5, v6, 4, v5
    s_mul_i32 s14, s48, 640
    s_mov_b32 s15, 0x20000
    s_lshl_b32 s48, s48, 3
    s_cmp_ge_u32 s46, 57
    s_cselect_b32 s49, 0x40000000, s49
    s_cmp_lt_u32 s46, 30
    s_cselect_b32 s12, s6, s56
    s_cselect_b32 s13, s7, s57
    s_add_u32 s20, s42, 17612800
    s_addc_u32 s21, s43, 0
    s_mov_b32 s22, 185856
    s_mov_b32 s23, 0x20000
    s_mov_b32 s24, s62
    s_mov_b32 s25, s63
    s_mov_b32 s26, 256
    s_mov_b32 s27, 0x20000
    buffer_load_dwordx4 v[68:71], v5, s[12:15], s49 offen
    s_add_u32 s49, s49, s48
    buffer_load_dwordx4 v[72:75], v5, s[12:15], s49 offen
    s_add_u32 s49, s49, s48
    buffer_load_dwordx4 v[76:79], v5, s[12:15], s49 offen
    s_add_u32 s49, s49, s48
    buffer_load_dwordx4 v[80:83], v5, s[12:15], s49 offen
    s_add_u32 s49, s49, s48
    buffer_load_dwordx4 v[84:87], v5, s[12:15], s49 offen
    s_add_u32 s49, s49, s48
    buffer_load_dwordx4 v[88:91], v5, s[12:15], s49 offen
    s_add_u32 s49, s49, s48
    buffer_load_dwordx4 v[92:95], v5, s[12:15], s49 offen
    s_add_u32 s49, s49, s48
    buffer_load_dwordx4 v[96:99], v5, s[12:15], s49 offen
    s_add_u32 s49, s49, s48
    buffer_load_dwordx4 v[100:103], v5, s[12:15], s49 offen
    s_add_u32 s49, s49, s48
    buffer_load_dwordx4 v[104:107], v5, s[12:15], s49 offen
    s_add_u32 s49, s49, s48
    buffer_load_dwordx4 v[108:111], v5, s[12:15], s49 offen
    s_add_u32 s49, s49, s48
    buffer_load_dwordx4 v[112:115], v5, s[12:15], s49 offen
    s_add_u32 s49, s49, s48
    buffer_load_dwordx4 v[116:119], v5, s[12:15], s49 offen
    s_add_u32 s49, s49, s48
    buffer_load_dwordx4 v[120:123], v5, s[12:15], s49 offen
    s_add_u32 s49, s49, s48
    buffer_load_dwordx4 v[124:127], v5, s[12:15], s49 offen
    s_add_u32 s49, s49, s48
    buffer_load_dwordx4 v[128:131], v5, s[12:15], s49 offen
    s_add_u32 s49, s49, s48
    buffer_load_dwordx4 v[132:135], v5, s[12:15], s49 offen
    s_add_u32 s49, s49, s48
    buffer_load_dwordx4 v[136:139], v5, s[12:15], s49 offen
    s_add_u32 s49, s49, s48
    buffer_load_dwordx4 v[140:143], v5, s[12:15], s49 offen
    s_add_u32 s49, s49, s48
    buffer_load_dwordx4 v[144:147], v5, s[12:15], s49 offen
    s_add_u32 s49, s49, s48
    buffer_load_dwordx4 v[148:151], v5, s[12:15], s49 offen
    s_add_u32 s49, s49, s48
    buffer_load_dwordx4 v[152:155], v5, s[12:15], s49 offen
    s_add_u32 s49, s49, s48
    buffer_load_dwordx4 v[156:159], v5, s[12:15], s49 offen
    s_add_u32 s49, s49, s48
    buffer_load_dwordx4 v[160:163], v5, s[12:15], s49 offen
    s_add_u32 s49, s49, s48
    buffer_load_dwordx4 v[164:167], v5, s[12:15], s49 offen
    s_add_u32 s49, s49, s48
    buffer_load_dwordx4 v[168:171], v5, s[12:15], s49 offen
    s_add_u32 s49, s49, s48
    buffer_load_dwordx4 v[172:175], v5, s[12:15], s49 offen
    s_add_u32 s49, s49, s48
    s_mul_i32 s50, s44, 3
    v_add_u32 v6, s50, v255
    v_lshlrev_b32 v6, 7, v6
    v_add_u32 v6, 120320, v6
    v_mov_b32 v7, 0
    s_mov_b64 exec, 7
    buffer_store_dword v7, v6, s[20:23], 0 offen sc1
    s_mov_b64 exec, -1
    s_mov_b32 s50, 1065369472
    s_mov_b32 s51, 0x3f80
    s_mov_b32 s52, 0x3f800000
    v_mov_b32 v180, 0
    v_mov_b32 v181, 0
    v_mov_b32 v182, 0
    v_mov_b32 v183, 0
    v_mov_b32 v184, 0
    v_mov_b32 v185, 0
    v_mov_b32 v186, 0
    v_mov_b32 v187, 0
    v_mov_b32 v190, 0
    v_mov_b32 v191, 0
    v_mov_b32 v192, 0
    v_mov_b32 v193, 0
    v_mov_b32 v194, 0
    v_mov_b32 v195, 0
    v_mov_b32 v196, 0
    v_mov_b32 v197, 0
    v_mov_b32 v198, 0
    v_mov_b32 v199, 0
    v_mov_b32 v200, 0
    v_mov_b32 v201, 0
    s_waitcnt vmcnt(38)
    v_dot2_f32_bf16 v190, v8, s50, v190
    v_dot2_f32_bf16 v192, v8, v8, v192
    v_dot2_f32_bf16 v191, v9, s50, v191
    v_dot2_f32_bf16 v193, v9, v9, v193
    v_dot2_f32_bf16 v190, v10, s50, v190
    v_dot2_f32_bf16 v192, v10, v10, v192
    v_dot2_f32_bf16 v191, v11, s50, v191
    v_dot2_f32_bf16 v193, v11, v11, v193
    v_dot2_f32_bf16 v190, v12, s50, v190
    v_dot2_f32_bf16 v192, v12, v12, v192
    v_dot2_f32_bf16 v191, v13, s50, v191
    v_dot2_f32_bf16 v193, v13, v13, v193
    v_dot2_f32_bf16 v190, v14, s50, v190
    v_dot2_f32_bf16 v192, v14, v14, v192
    v_dot2_f32_bf16 v191, v15, s50, v191
    v_dot2_f32_bf16 v193, v15, v15, v193
    v_dot2_f32_bf16 v190, v16, s50, v190
    v_dot2_f32_bf16 v192, v16, v16, v192
    v_dot2_f32_bf16 v191, v17, s50, v191
    v_dot2_f32_bf16 v193, v17, v17, v193
    v_dot2_f32_bf16 v190, v18, s50, v190
    v_dot2_f32_bf16 v192, v18, v18, v192
    v_dot2_f32_bf16 v191, v19, s50, v191
    v_dot2_f32_bf16 v193, v19, v19, v193
    v_dot2_f32_bf16 v190, v20, s50, v190
    v_dot2_f32_bf16 v192, v20, v20, v192
    v_dot2_f32_bf16 v191, v21, s50, v191
    v_dot2_f32_bf16 v193, v21, v21, v193
    v_dot2_f32_bf16 v190, v22, s50, v190
    v_dot2_f32_bf16 v192, v22, v22, v192
    v_dot2_f32_bf16 v191, v23, s50, v191
    v_dot2_f32_bf16 v193, v23, v23, v193
    v_dot2_f32_bf16 v190, v24, s50, v190
    v_dot2_f32_bf16 v192, v24, v24, v192
    v_dot2_f32_bf16 v191, v25, s50, v191
    v_dot2_f32_bf16 v193, v25, v25, v193
    v_dot2_f32_bf16 v190, v26, s50, v190
    v_dot2_f32_bf16 v192, v26, v26, v192
    v_dot2_f32_bf16 v191, v27, s50, v191
    v_dot2_f32_bf16 v193, v27, v27, v193
    s_waitcnt vmcnt(33)
    v_dot2_f32_bf16 v194, v28, s50, v194
    v_dot2_f32_bf16 v196, v28, v28, v196
    v_dot2_f32_bf16 v195, v29, s50, v195
    v_dot2_f32_bf16 v197, v29, v29, v197
    v_dot2_f32_bf16 v194, v30, s50, v194
    v_dot2_f32_bf16 v196, v30, v30, v196
    v_dot2_f32_bf16 v195, v31, s50, v195
    v_dot2_f32_bf16 v197, v31, v31, v197
    v_dot2_f32_bf16 v194, v32, s50, v194
    v_dot2_f32_bf16 v196, v32, v32, v196
    v_dot2_f32_bf16 v195, v33, s50, v195
    v_dot2_f32_bf16 v197, v33, v33, v197
    v_dot2_f32_bf16 v194, v34, s50, v194
    v_dot2_f32_bf16 v196, v34, v34, v196
    v_dot2_f32_bf16 v195, v35, s50, v195
    v_dot2_f32_bf16 v197, v35, v35, v197
    v_dot2_f32_bf16 v194, v36, s50, v194
    v_dot2_f32_bf16 v196, v36, v36, v196
    v_dot2_f32_bf16 v195, v37, s50, v195
    v_dot2_f32_bf16 v197, v37, v37, v197
    v_dot2_f32_bf16 v194, v38, s50, v194
    v_dot2_f32_bf16 v196, v38, v38, v196
    v_dot2_f32_bf16 v195, v39, s50, v195
    v_dot2_f32_bf16 v197, v39, v39, v197
    v_dot2_f32_bf16 v194, v40, s50, v194
    v_dot2_f32_bf16 v196, v40, v40, v196
    v_dot2_f32_bf16 v195, v41, s50, v195
    v_dot2_f32_bf16 v197, v41, v41, v197
    v_dot2_f32_bf16 v194, v42, s50, v194
    v_dot2_f32_bf16 v196, v42, v42, v196
    v_dot2_f32_bf16 v195, v43, s50, v195
    v_dot2_f32_bf16 v197, v43, v43, v197
    v_dot2_f32_bf16 v194, v44, s50, v194
    v_dot2_f32_bf16 v196, v44, v44, v196
    v_dot2_f32_bf16 v195, v45, s50, v195
    v_dot2_f32_bf16 v197, v45, v45, v197
    v_dot2_f32_bf16 v194, v46, s50, v194
    v_dot2_f32_bf16 v196, v46, v46, v196
    v_dot2_f32_bf16 v195, v47, s50, v195
    v_dot2_f32_bf16 v197, v47, v47, v197
    s_waitcnt vmcnt(28)
    v_dot2_f32_bf16 v198, v48, s50, v198
    v_dot2_f32_bf16 v200, v48, v48, v200
    v_dot2_f32_bf16 v199, v49, s50, v199
    v_dot2_f32_bf16 v201, v49, v49, v201
    v_dot2_f32_bf16 v198, v50, s50, v198
    v_dot2_f32_bf16 v200, v50, v50, v200
    v_dot2_f32_bf16 v199, v51, s50, v199
    v_dot2_f32_bf16 v201, v51, v51, v201
    v_dot2_f32_bf16 v198, v52, s50, v198
    v_dot2_f32_bf16 v200, v52, v52, v200
    v_dot2_f32_bf16 v199, v53, s50, v199
    v_dot2_f32_bf16 v201, v53, v53, v201
    v_dot2_f32_bf16 v198, v54, s50, v198
    v_dot2_f32_bf16 v200, v54, v54, v200
    v_dot2_f32_bf16 v199, v55, s50, v199
    v_dot2_f32_bf16 v201, v55, v55, v201
    v_dot2_f32_bf16 v198, v56, s50, v198
    v_dot2_f32_bf16 v200, v56, v56, v200
    v_dot2_f32_bf16 v199, v57, s50, v199
    v_dot2_f32_bf16 v201, v57, v57, v201
    v_dot2_f32_bf16 v198, v58, s50, v198
    v_dot2_f32_bf16 v200, v58, v58, v200
    v_dot2_f32_bf16 v199, v59, s50, v199
    v_dot2_f32_bf16 v201, v59, v59, v201
    v_dot2_f32_bf16 v198, v60, s50, v198
    v_dot2_f32_bf16 v200, v60, v60, v200
    v_dot2_f32_bf16 v199, v61, s50, v199
    v_dot2_f32_bf16 v201, v61, v61, v201
    v_dot2_f32_bf16 v198, v62, s50, v198
    v_dot2_f32_bf16 v200, v62, v62, v200
    v_dot2_f32_bf16 v199, v63, s50, v199
    v_dot2_f32_bf16 v201, v63, v63, v201
    v_dot2_f32_bf16 v198, v64, s50, v198
    v_dot2_f32_bf16 v200, v64, v64, v200
    v_dot2_f32_bf16 v199, v65, s50, v199
    v_dot2_f32_bf16 v201, v65, v65, v201
    v_dot2_f32_bf16 v198, v66, s50, v198
    v_dot2_f32_bf16 v200, v66, v66, v200
    v_dot2_f32_bf16 v199, v67, s50, v199
    v_dot2_f32_bf16 v201, v67, v67, v201
    s_nop 2
    v_add_f32 v190, v190, v191
    v_add_f32 v192, v192, v193
    v_add_f32 v194, v194, v195
    v_add_f32 v196, v196, v197
    v_add_f32 v198, v198, v199
    v_add_f32 v200, v200, v201
    v_add_f32_dpp v190, v190, v190 quad_perm:[1,0,3,2] row_mask:0xf bank_mask:0xf
    v_add_f32_dpp v192, v192, v192 quad_perm:[1,0,3,2] row_mask:0xf bank_mask:0xf
    v_add_f32_dpp v194, v194, v194 quad_perm:[1,0,3,2] row_mask:0xf bank_mask:0xf
    v_add_f32_dpp v196, v196, v196 quad_perm:[1,0,3,2] row_mask:0xf bank_mask:0xf
    v_add_f32_dpp v198, v198, v198 quad_perm:[1,0,3,2] row_mask:0xf bank_mask:0xf
    v_add_f32_dpp v200, v200, v200 quad_perm:[1,0,3,2] row_mask:0xf bank_mask:0xf
    v_add_f32_dpp v190, v190, v190 quad_perm:[2,3,0,1] row_mask:0xf bank_mask:0xf
    v_add_f32_dpp v192, v192, v192 quad_perm:[2,3,0,1] row_mask:0xf bank_mask:0xf
    v_add_f32_dpp v194, v194, v194 quad_perm:[2,3,0,1] row_mask:0xf bank_mask:0xf
    v_add_f32_dpp v196, v196, v196 quad_perm:[2,3,0,1] row_mask:0xf bank_mask:0xf
    v_add_f32_dpp v198, v198, v198 quad_perm:[2,3,0,1] row_mask:0xf bank_mask:0xf
    v_add_f32_dpp v200, v200, v200 quad_perm:[2,3,0,1] row_mask:0xf bank_mask:0xf
    v_add_f32_dpp v190, v190, v190 row_half_mirror row_mask:0xf bank_mask:0xf
    v_add_f32_dpp v192, v192, v192 row_half_mirror row_mask:0xf bank_mask:0xf
    v_add_f32_dpp v194, v194, v194 row_half_mirror row_mask:0xf bank_mask:0xf
    v_add_f32_dpp v196, v196, v196 row_half_mirror row_mask:0xf bank_mask:0xf
    v_add_f32_dpp v198, v198, v198 row_half_mirror row_mask:0xf bank_mask:0xf
    v_add_f32_dpp v200, v200, v200 row_half_mirror row_mask:0xf bank_mask:0xf
    v_add_f32_dpp v190, v190, v190 row_mirror row_mask:0xf bank_mask:0xf
    v_add_f32_dpp v192, v192, v192 row_mirror row_mask:0xf bank_mask:0xf
    v_add_f32_dpp v194, v194, v194 row_mirror row_mask:0xf bank_mask:0xf
    v_add_f32_dpp v196, v196, v196 row_mirror row_mask:0xf bank_mask:0xf
    v_add_f32_dpp v198, v198, v198 row_mirror row_mask:0xf bank_mask:0xf
    v_add_f32_dpp v200, v200, v200 row_mirror row_mask:0xf bank_mask:0xf
    v_mul_f32 v191, 3133983949, v190
    v_mul_f32 v195, 3133983949, v194
    v_mul_f32 v199, 3133983949, v198
    v_mul_f32 v192, 986500301, v192
    v_mul_f32 v196, 986500301, v196
    v_mul_f32 v200, 986500301, v200
    v_fma_f32 v192, -v191, v191, v192
    v_fma_f32 v196, -v195, v195, v196
    v_fma_f32 v200, -v199, v199, v200
    v_max_f32 v192, 0, v192
    v_max_f32 v196, 0, v196
    v_max_f32 v200, 0, v200
    v_add_f32 v192, 925353388, v192
    v_add_f32 v196, 925353388, v196
    v_add_f32 v200, 925353388, v200
    v_rsq_f32 v190, v192
    v_rsq_f32 v194, v196
    v_rsq_f32 v198, v200
    s_cmp_lt_u32 s44, 128
    s_mov_b32 s53, 0x40000000
    s_cselect_b32 s53, 12288, s53
    s_movk_i32 s54, 6144
    s_mov_b32 exec_lo, 0x10001
    s_mov_b32 exec_hi, 0x10001
    buffer_store_dwordx2 v[190:191], v4, s[20:23], 0 offen sc1
    buffer_store_dwordx2 v[194:195], v4, s[20:23], s54 offen sc1
    buffer_store_dwordx2 v[198:199], v4, s[20:23], s53 offen sc1
    s_mov_b64 exec, -1
    s_waitcnt vmcnt(28)
    v_dot2_f32_bf16 v180, v68, s51, v180
    v_dot2_f32_bf16 v181, v68, s52, v181
    v_dot2_f32_bf16 v182, v69, s51, v182
    v_dot2_f32_bf16 v183, v69, s52, v183
    v_dot2_f32_bf16 v184, v70, s51, v184
    v_dot2_f32_bf16 v185, v70, s52, v185
    v_dot2_f32_bf16 v186, v71, s51, v186
    v_dot2_f32_bf16 v187, v71, s52, v187
    v_dot2_f32_bf16 v180, v72, s51, v180
    v_dot2_f32_bf16 v181, v72, s52, v181
    v_dot2_f32_bf16 v182, v73, s51, v182
    v_dot2_f32_bf16 v183, v73, s52, v183
    v_dot2_f32_bf16 v184, v74, s51, v184
    v_dot2_f32_bf16 v185, v74, s52, v185
    v_dot2_f32_bf16 v186, v75, s51, v186
    v_dot2_f32_bf16 v187, v75, s52, v187
    v_dot2_f32_bf16 v180, v76, s51, v180
    v_dot2_f32_bf16 v181, v76, s52, v181
    v_dot2_f32_bf16 v182, v77, s51, v182
    v_dot2_f32_bf16 v183, v77, s52, v183
    v_dot2_f32_bf16 v184, v78, s51, v184
    v_dot2_f32_bf16 v185, v78, s52, v185
    v_dot2_f32_bf16 v186, v79, s51, v186
    v_dot2_f32_bf16 v187, v79, s52, v187
    s_waitcnt vmcnt(25)
    v_dot2_f32_bf16 v180, v80, s51, v180
    v_dot2_f32_bf16 v181, v80, s52, v181
    v_dot2_f32_bf16 v182, v81, s51, v182
    v_dot2_f32_bf16 v183, v81, s52, v183
    v_dot2_f32_bf16 v184, v82, s51, v184
    v_dot2_f32_bf16 v185, v82, s52, v185
    v_dot2_f32_bf16 v186, v83, s51, v186
    v_dot2_f32_bf16 v187, v83, s52, v187
    v_dot2_f32_bf16 v180, v84, s51, v180
    v_dot2_f32_bf16 v181, v84, s52, v181
    v_dot2_f32_bf16 v182, v85, s51, v182
    v_dot2_f32_bf16 v183, v85, s52, v183
    v_dot2_f32_bf16 v184, v86, s51, v184
    v_dot2_f32_bf16 v185, v86, s52, v185
    v_dot2_f32_bf16 v186, v87, s51, v186
    v_dot2_f32_bf16 v187, v87, s52, v187
    v_dot2_f32_bf16 v180, v88, s51, v180
    v_dot2_f32_bf16 v181, v88, s52, v181
    v_dot2_f32_bf16 v182, v89, s51, v182
    v_dot2_f32_bf16 v183, v89, s52, v183
    v_dot2_f32_bf16 v184, v90, s51, v184
    v_dot2_f32_bf16 v185, v90, s52, v185
    v_dot2_f32_bf16 v186, v91, s51, v186
    v_dot2_f32_bf16 v187, v91, s52, v187
    s_waitcnt vmcnt(22)
    v_dot2_f32_bf16 v180, v92, s51, v180
    v_dot2_f32_bf16 v181, v92, s52, v181
    v_dot2_f32_bf16 v182, v93, s51, v182
    v_dot2_f32_bf16 v183, v93, s52, v183
    v_dot2_f32_bf16 v184, v94, s51, v184
    v_dot2_f32_bf16 v185, v94, s52, v185
    v_dot2_f32_bf16 v186, v95, s51, v186
    v_dot2_f32_bf16 v187, v95, s52, v187
    v_dot2_f32_bf16 v180, v96, s51, v180
    v_dot2_f32_bf16 v181, v96, s52, v181
    v_dot2_f32_bf16 v182, v97, s51, v182
    v_dot2_f32_bf16 v183, v97, s52, v183
    v_dot2_f32_bf16 v184, v98, s51, v184
    v_dot2_f32_bf16 v185, v98, s52, v185
    v_dot2_f32_bf16 v186, v99, s51, v186
    v_dot2_f32_bf16 v187, v99, s52, v187
    v_dot2_f32_bf16 v180, v100, s51, v180
    v_dot2_f32_bf16 v181, v100, s52, v181
    v_dot2_f32_bf16 v182, v101, s51, v182
    v_dot2_f32_bf16 v183, v101, s52, v183
    v_dot2_f32_bf16 v184, v102, s51, v184
    v_dot2_f32_bf16 v185, v102, s52, v185
    v_dot2_f32_bf16 v186, v103, s51, v186
    v_dot2_f32_bf16 v187, v103, s52, v187
    s_waitcnt vmcnt(19)
    v_dot2_f32_bf16 v180, v104, s51, v180
    v_dot2_f32_bf16 v181, v104, s52, v181
    v_dot2_f32_bf16 v182, v105, s51, v182
    v_dot2_f32_bf16 v183, v105, s52, v183
    v_dot2_f32_bf16 v184, v106, s51, v184
    v_dot2_f32_bf16 v185, v106, s52, v185
    v_dot2_f32_bf16 v186, v107, s51, v186
    v_dot2_f32_bf16 v187, v107, s52, v187
    v_dot2_f32_bf16 v180, v108, s51, v180
    v_dot2_f32_bf16 v181, v108, s52, v181
    v_dot2_f32_bf16 v182, v109, s51, v182
    v_dot2_f32_bf16 v183, v109, s52, v183
    v_dot2_f32_bf16 v184, v110, s51, v184
    v_dot2_f32_bf16 v185, v110, s52, v185
    v_dot2_f32_bf16 v186, v111, s51, v186
    v_dot2_f32_bf16 v187, v111, s52, v187
    v_dot2_f32_bf16 v180, v112, s51, v180
    v_dot2_f32_bf16 v181, v112, s52, v181
    v_dot2_f32_bf16 v182, v113, s51, v182
    v_dot2_f32_bf16 v183, v113, s52, v183
    v_dot2_f32_bf16 v184, v114, s51, v184
    v_dot2_f32_bf16 v185, v114, s52, v185
    v_dot2_f32_bf16 v186, v115, s51, v186
    v_dot2_f32_bf16 v187, v115, s52, v187
    s_waitcnt vmcnt(16)
    v_dot2_f32_bf16 v180, v116, s51, v180
    v_dot2_f32_bf16 v181, v116, s52, v181
    v_dot2_f32_bf16 v182, v117, s51, v182
    v_dot2_f32_bf16 v183, v117, s52, v183
    v_dot2_f32_bf16 v184, v118, s51, v184
    v_dot2_f32_bf16 v185, v118, s52, v185
    v_dot2_f32_bf16 v186, v119, s51, v186
    v_dot2_f32_bf16 v187, v119, s52, v187
    v_dot2_f32_bf16 v180, v120, s51, v180
    v_dot2_f32_bf16 v181, v120, s52, v181
    v_dot2_f32_bf16 v182, v121, s51, v182
    v_dot2_f32_bf16 v183, v121, s52, v183
    v_dot2_f32_bf16 v184, v122, s51, v184
    v_dot2_f32_bf16 v185, v122, s52, v185
    v_dot2_f32_bf16 v186, v123, s51, v186
    v_dot2_f32_bf16 v187, v123, s52, v187
    v_dot2_f32_bf16 v180, v124, s51, v180
    v_dot2_f32_bf16 v181, v124, s52, v181
    v_dot2_f32_bf16 v182, v125, s51, v182
    v_dot2_f32_bf16 v183, v125, s52, v183
    v_dot2_f32_bf16 v184, v126, s51, v184
    v_dot2_f32_bf16 v185, v126, s52, v185
    v_dot2_f32_bf16 v186, v127, s51, v186
    v_dot2_f32_bf16 v187, v127, s52, v187
    s_waitcnt vmcnt(13)
    v_dot2_f32_bf16 v180, v128, s51, v180
    v_dot2_f32_bf16 v181, v128, s52, v181
    v_dot2_f32_bf16 v182, v129, s51, v182
    v_dot2_f32_bf16 v183, v129, s52, v183
    v_dot2_f32_bf16 v184, v130, s51, v184
    v_dot2_f32_bf16 v185, v130, s52, v185
    v_dot2_f32_bf16 v186, v131, s51, v186
    v_dot2_f32_bf16 v187, v131, s52, v187
    v_dot2_f32_bf16 v180, v132, s51, v180
    v_dot2_f32_bf16 v181, v132, s52, v181
    v_dot2_f32_bf16 v182, v133, s51, v182
    v_dot2_f32_bf16 v183, v133, s52, v183
    v_dot2_f32_bf16 v184, v134, s51, v184
    v_dot2_f32_bf16 v185, v134, s52, v185
    v_dot2_f32_bf16 v186, v135, s51, v186
    v_dot2_f32_bf16 v187, v135, s52, v187
    v_dot2_f32_bf16 v180, v136, s51, v180
    v_dot2_f32_bf16 v181, v136, s52, v181
    v_dot2_f32_bf16 v182, v137, s51, v182
    v_dot2_f32_bf16 v183, v137, s52, v183
    v_dot2_f32_bf16 v184, v138, s51, v184
    v_dot2_f32_bf16 v185, v138, s52, v185
    v_dot2_f32_bf16 v186, v139, s51, v186
    v_dot2_f32_bf16 v187, v139, s52, v187
    s_waitcnt vmcnt(10)
    v_dot2_f32_bf16 v180, v140, s51, v180
    v_dot2_f32_bf16 v181, v140, s52, v181
    v_dot2_f32_bf16 v182, v141, s51, v182
    v_dot2_f32_bf16 v183, v141, s52, v183
    v_dot2_f32_bf16 v184, v142, s51, v184
    v_dot2_f32_bf16 v185, v142, s52, v185
    v_dot2_f32_bf16 v186, v143, s51, v186
    v_dot2_f32_bf16 v187, v143, s52, v187
    v_dot2_f32_bf16 v180, v144, s51, v180
    v_dot2_f32_bf16 v181, v144, s52, v181
    v_dot2_f32_bf16 v182, v145, s51, v182
    v_dot2_f32_bf16 v183, v145, s52, v183
    v_dot2_f32_bf16 v184, v146, s51, v184
    v_dot2_f32_bf16 v185, v146, s52, v185
    v_dot2_f32_bf16 v186, v147, s51, v186
    v_dot2_f32_bf16 v187, v147, s52, v187
    v_dot2_f32_bf16 v180, v148, s51, v180
    v_dot2_f32_bf16 v181, v148, s52, v181
    v_dot2_f32_bf16 v182, v149, s51, v182
    v_dot2_f32_bf16 v183, v149, s52, v183
    v_dot2_f32_bf16 v184, v150, s51, v184
    v_dot2_f32_bf16 v185, v150, s52, v185
    v_dot2_f32_bf16 v186, v151, s51, v186
    v_dot2_f32_bf16 v187, v151, s52, v187
    s_waitcnt vmcnt(7)
    v_dot2_f32_bf16 v180, v152, s51, v180
    v_dot2_f32_bf16 v181, v152, s52, v181
    v_dot2_f32_bf16 v182, v153, s51, v182
    v_dot2_f32_bf16 v183, v153, s52, v183
    v_dot2_f32_bf16 v184, v154, s51, v184
    v_dot2_f32_bf16 v185, v154, s52, v185
    v_dot2_f32_bf16 v186, v155, s51, v186
    v_dot2_f32_bf16 v187, v155, s52, v187
    v_dot2_f32_bf16 v180, v156, s51, v180
    v_dot2_f32_bf16 v181, v156, s52, v181
    v_dot2_f32_bf16 v182, v157, s51, v182
    v_dot2_f32_bf16 v183, v157, s52, v183
    v_dot2_f32_bf16 v184, v158, s51, v184
    v_dot2_f32_bf16 v185, v158, s52, v185
    v_dot2_f32_bf16 v186, v159, s51, v186
    v_dot2_f32_bf16 v187, v159, s52, v187
    v_dot2_f32_bf16 v180, v160, s51, v180
    v_dot2_f32_bf16 v181, v160, s52, v181
    v_dot2_f32_bf16 v182, v161, s51, v182
    v_dot2_f32_bf16 v183, v161, s52, v183
    v_dot2_f32_bf16 v184, v162, s51, v184
    v_dot2_f32_bf16 v185, v162, s52, v185
    v_dot2_f32_bf16 v186, v163, s51, v186
    v_dot2_f32_bf16 v187, v163, s52, v187
    s_waitcnt vmcnt(4)
    v_dot2_f32_bf16 v180, v164, s51, v180
    v_dot2_f32_bf16 v181, v164, s52, v181
    v_dot2_f32_bf16 v182, v165, s51, v182
    v_dot2_f32_bf16 v183, v165, s52, v183
    v_dot2_f32_bf16 v184, v166, s51, v184
    v_dot2_f32_bf16 v185, v166, s52, v185
    v_dot2_f32_bf16 v186, v167, s51, v186
    v_dot2_f32_bf16 v187, v167, s52, v187
    v_dot2_f32_bf16 v180, v168, s51, v180
    v_dot2_f32_bf16 v181, v168, s52, v181
    v_dot2_f32_bf16 v182, v169, s51, v182
    v_dot2_f32_bf16 v183, v169, s52, v183
    v_dot2_f32_bf16 v184, v170, s51, v184
    v_dot2_f32_bf16 v185, v170, s52, v185
    v_dot2_f32_bf16 v186, v171, s51, v186
    v_dot2_f32_bf16 v187, v171, s52, v187
    v_dot2_f32_bf16 v180, v172, s51, v180
    v_dot2_f32_bf16 v181, v172, s52, v181
    v_dot2_f32_bf16 v182, v173, s51, v182
    v_dot2_f32_bf16 v183, v173, s52, v183
    v_dot2_f32_bf16 v184, v174, s51, v184
    v_dot2_f32_bf16 v185, v174, s52, v185
    v_dot2_f32_bf16 v186, v175, s51, v186
    v_dot2_f32_bf16 v187, v175, s52, v187
    s_nop 1
    s_nop 1
    v_permlane32_swap_b32 v180, v184
    v_permlane32_swap_b32 v181, v185
    v_permlane32_swap_b32 v182, v186
    v_permlane32_swap_b32 v183, v187
    s_nop 0
    v_add_f32 v180, v180, v184
    v_add_f32 v181, v181, v185
    v_add_f32 v182, v182, v186
    v_add_f32 v183, v183, v187
    s_nop 1
    v_permlane16_swap_b32 v180, v182
    v_permlane16_swap_b32 v181, v183
    s_nop 0
    v_add_f32 v180, v180, v182
    v_add_f32 v181, v181, v183
    v_and_b32 v2, 8, v255
    v_cmp_ne_u32 vcc, 0, v2
    v_add_f32_dpp v180, v180, v180 row_ror:8 row_mask:0xf bank_mask:0xf
    v_add_f32_dpp v181, v181, v181 row_ror:8 row_mask:0xf bank_mask:0xf
    v_and_b32 v3, 7, v255
    v_lshrrev_b32 v4, 5, v255
    v_lshl_add_u32 v3, v3, 1, v4
    v_cndmask_b32 v180, v180, v181, vcc
    v_bfe_u32 v4, v255, 4, 1
    v_lshrrev_b32 v2, 1, v2
    v_lshl_add_u32 v4, v4, 3, v2
    v_lshl_add_u32 v3, v3, 4, v4
    s_lshl_b32 s49, s46, 8
    s_mul_i32 s47, s47, 14848
    s_add_u32 s49, s49, s47
    s_add_u32 s49, s49, 16384
    s_cmp_ge_u32 s46, 57
    s_cselect_b32 s49, 0x40000000, s49
    buffer_store_dword v180, v3, s[20:23], s49 offen sc1
    v_and_b32 v94, 3, v255
    v_lshlrev_b32 v94, 6, v94
    s_lshl_b32 s45, s45, 6
    v_mov_b32 v2, s45
    v_mov_b32 v3, 1
    v_mov_b32 v4, 0
    v_mov_b32 v5, 0
    v_mov_b32 v6, 0
    v_mov_b32 v7, 0
    v_mov_b32 v8, 162304
    ds_write_b128 v8, v[4:7]
    s_waitcnt vmcnt(0) lgkmcnt(0)
    s_barrier
    s_cmp_lg_u32 s32, 5
    s_cbranch_scc1 L_st_join
    s_mov_b64 exec, 1
    buffer_atomic_add v3, v2, s[24:27], 0 offen sc1
    s_mov_b32 exec_lo, 15
    s_mov_b32 exec_hi, 0
    s_mov_b32 s53, 0
L_poll_p0s_13:
    s_sleep 40
    buffer_load_dword v93, v94, s[24:27], 0 offen sc1
    s_add_u32 s53, s53, 1
    s_waitcnt vmcnt(0)
    v_cmp_gt_u32 vcc, 6, v93
    s_cmp_gt_u32 s53, 32768
    s_cbranch_scc1 L_polled_p0s_14
    s_cbranch_vccz L_polled_p0s_14
    s_sleep 1
    s_branch L_poll_p0s_13
L_polled_p0s_14:
    s_mov_b64 exec, -1
L_st_join:
    s_mov_b32 s34, 29
    s_mov_b32 s35, 4
    v_mov_b32 v236, 0
    v_mov_b32 v237, 0
    v_mov_b32 v238, 0
    v_mov_b32 v239, 0
    s_mov_b32 s33, s37
    s_cmp_lt_u32 s32, 4
    s_cbranch_scc1 L_epi_done
    s_sub_u32 s44, s32, 4
    s_branch L_b_phase2b
L_fallback:
    s_waitcnt lgkmcnt(0)
    s_mov_b32 s51, 0xffff
    s_mov_b32 s46, 1
    v_and_b32 v146, 31, v255
    v_lshrrev_b32 v147, 5, v255
    v_lshlrev_b32 v147, 6, v147
    v_lshrrev_b32 v148, 2, v146
    v_lshl_add_u32 v147, v148, 8, v147
    v_and_b32 v148, 3, v146
    v_lshl_add_u32 v158, v148, 4, v147
    v_cmp_eq_u32 s[54:55], 20, v146
    v_cmp_lt_u32 vcc, 31, v255
    v_mov_b32 v154, 0xff800000
    v_mov_b32 v155, 0xff800000
    v_mov_b32 v136, 1065369472
    v_mov_b32 v137, 0x3f80
    v_cndmask_b32 v128, 0, v136, s[54:55]
    v_cndmask_b32 v129, 0, v136, s[54:55]
    v_cndmask_b32 v130, 0, v136, s[54:55]
    v_cndmask_b32 v131, 0, v136, s[54:55]
    v_cndmask_b32 v132, 0, v136, s[54:55]
    v_cndmask_b32 v133, 0, v136, s[54:55]
    v_cndmask_b32 v134, 0, v136, s[54:55]
    v_cndmask_b32 v135, 0, v136, s[54:55]
    v_cndmask_b32_e64 v116, v116, 0, vcc
    v_cndmask_b32_e64 v117, v117, 0, vcc
    v_cndmask_b32_e64 v122, v122, 0, vcc
    v_cndmask_b32_e64 v123, v123, 0, vcc
    s_mov_b32 s38, s49
    s_mov_b32 s48, 0
L_fb1:
    buffer_load_dwordx2 v[124:125], v144, s[16:19], s38 offen
    buffer_load_dwordx2 v[126:127], v144, s[16:19], s38 offen offset:512
    s_mov_b32 exec_hi, 0
    buffer_load_dwordx2 v[136:137], v144, s[16:19], s38 offen offset:1024
    s_mov_b32 exec_hi, -1
    s_waitcnt vmcnt(0)
    v_mfma_f32_32x32x16_bf16 v[0:15], v[124:127], v[112:115], 0
    v_mfma_f32_32x32x16_bf16 v[32:47], v[124:127], v[118:121], 0
    v_mfma_f32_32x32x8_bf16 v[0:15], v[136:137], v[116:117], v[0:15]
    v_mfma_f32_32x32x8_bf16 v[32:47], v[136:137], v[122:123], v[32:47]
    s_nop 15
    v_max3_f32 v154, v154, v0, v1
    v_max3_f32 v154, v154, v2, v3
    v_max3_f32 v154, v154, v4, v5
    v_max3_f32 v154, v154, v6, v7
    v_max3_f32 v154, v154, v8, v9
    v_max3_f32 v154, v154, v10, v11
    v_max3_f32 v154, v154, v12, v13
    v_max3_f32 v154, v154, v14, v15
    v_max3_f32 v155, v155, v32, v33
    v_max3_f32 v155, v155, v34, v35
    v_max3_f32 v155, v155, v36, v37
    v_max3_f32 v155, v155, v38, v39
    v_max3_f32 v155, v155, v40, v41
    v_max3_f32 v155, v155, v42, v43
    v_max3_f32 v155, v155, v44, v45
    v_max3_f32 v155, v155, v46, v47
    s_add_u32 s38, s38, 2560
    s_add_u32 s48, s48, 1
    s_cmp_lt_u32 s48, 64
    s_cbranch_scc1 L_fb1
    v_mov_b32 v146, v154
    v_mov_b32 v147, v155
    s_mov_b32 s50, 3267887104
    v_cmp_lt_u32 vcc, 31, v255
    v_permlane32_swap_b32 v146, v154
    v_permlane32_swap_b32 v147, v155
    s_nop 0
    v_max_f32 v154, v154, v146
    v_max_f32 v155, v155, v147
    v_sub_f32 v152, s50, v154
    v_sub_f32 v153, s50, v155
    v_cvt_pk_bf16_f32 v146, v152, v152
    v_and_b32 v147, 0xffff0000, v146
    v_sub_f32 v154, v152, v147
    v_cvt_pk_bf16_f32 v147, v154, v154
    v_and_b32 v148, 0xffff0000, v147
    v_sub_f32 v154, v154, v148
    v_cvt_pk_bf16_f32 v154, v154, 0
    v_and_or_b32 v146, v146, s51, v148
    v_cndmask_b32 v116, v116, v146, vcc
    v_cndmask_b32 v117, v117, v154, vcc
    v_cvt_pk_bf16_f32 v149, v153, v153
    v_and_b32 v150, 0xffff0000, v149
    v_sub_f32 v155, v153, v150
    v_cvt_pk_bf16_f32 v150, v155, v155
    v_and_b32 v151, 0xffff0000, v150
    v_sub_f32 v155, v155, v151
    v_cvt_pk_bf16_f32 v155, v155, 0
    v_and_or_b32 v149, v149, s51, v151
    v_cndmask_b32 v122, v122, v149, vcc
    v_cndmask_b32 v123, v123, v155, vcc
    v_mov_b32 v64, 0
    v_mov_b32 v65, 0
    v_mov_b32 v66, 0
    v_mov_b32 v67, 0
    v_mov_b32 v68, 0
    v_mov_b32 v69, 0
    v_mov_b32 v70, 0
    v_mov_b32 v71, 0
    v_mov_b32 v72, 0
    v_mov_b32 v73, 0
    v_mov_b32 v74, 0
    v_mov_b32 v75, 0
    v_mov_b32 v76, 0
    v_mov_b32 v77, 0
    v_mov_b32 v78, 0
    v_mov_b32 v79, 0
    v_mov_b32 v80, 0
    v_mov_b32 v81, 0
    v_mov_b32 v82, 0
    v_mov_b32 v83, 0
    v_mov_b32 v84, 0
    v_mov_b32 v85, 0
    v_mov_b32 v86, 0
    v_mov_b32 v87, 0
    v_mov_b32 v88, 0
    v_mov_b32 v89, 0
    v_mov_b32 v90, 0
    v_mov_b32 v91, 0
    v_mov_b32 v92, 0
    v_mov_b32 v93, 0
    v_mov_b32 v94, 0
    v_mov_b32 v95, 0
    s_mov_b32 s38, s49
    s_mov_b32 s48, 0
L_fb2:
    buffer_load_dwordx2 v[124:125], v144, s[16:19], s38 offen
    buffer_load_dwordx2 v[126:127], v144, s[16:19], s38 offen offset:512
    s_mov_b32 exec_hi, 0
    buffer_load_dwordx2 v[136:137], v144, s[16:19], s38 offen offset:1024
    s_mov_b32 exec_hi, -1
    s_mov_b32 exec_lo, 0xfffff
    s_mov_b32 exec_hi, 0xfffff
    buffer_load_dwordx4 v[128:131], v158, s[16:19], s38 offen offset:1280
    buffer_load_dwordx4 v[132:135], v158, s[16:19], s38 offen offset:1408
    s_mov_b64 exec, -1
    s_waitcnt vmcnt(0)
    v_mfma_f32_32x32x16_bf16 v[0:15], v[124:127], v[112:115], 0
    v_mfma_f32_32x32x16_bf16 v[32:47], v[124:127], v[118:121], 0
    v_mfma_f32_32x32x8_bf16 v[0:15], v[136:137], v[116:117], v[0:15]
    v_mfma_f32_32x32x8_bf16 v[32:47], v[136:137], v[122:123], v[32:47]
    s_nop 15
    v_exp_f32 v0, v0
    v_exp_f32 v1, v1
    v_exp_f32 v2, v2
    v_exp_f32 v3, v3
    v_exp_f32 v4, v4
    v_exp_f32 v5, v5
    v_exp_f32 v6, v6
    v_exp_f32 v7, v7
    v_exp_f32 v8, v8
    v_exp_f32 v9, v9
    v_exp_f32 v10, v10
    v_exp_f32 v11, v11
    v_exp_f32 v12, v12
    v_exp_f32 v13, v13
    v_exp_f32 v14, v14
    v_exp_f32 v15, v15
    v_exp_f32 v32, v32
    v_exp_f32 v33, v33
    v_exp_f32 v34, v34
    v_exp_f32 v35, v35
    v_exp_f32 v36, v36
    v_exp_f32 v37, v37
    v_exp_f32 v38, v38
    v_exp_f32 v39, v39
    v_exp_f32 v40, v40
    v_exp_f32 v41, v41
    v_exp_f32 v42, v42
    v_exp_f32 v43, v43
    v_exp_f32 v44, v44
    v_exp_f32 v45, v45
    v_exp_f32 v46, v46
    v_exp_f32 v47, v47
    v_cvt_pk_bf16_f32 v96, v0, v1
    v_cvt_pk_bf16_f32 v97, v2, v3
    v_cvt_pk_bf16_f32 v98, v4, v5
    v_cvt_pk_bf16_f32 v99, v6, v7
    v_cvt_pk_bf16_f32 v100, v8, v9
    v_cvt_pk_bf16_f32 v101, v10, v11
    v_cvt_pk_bf16_f32 v102, v12, v13
    v_cvt_pk_bf16_f32 v103, v14, v15
    v_cvt_pk_bf16_f32 v104, v32, v33
    v_cvt_pk_bf16_f32 v105, v34, v35
    v_cvt_pk_bf16_f32 v106, v36, v37
    v_cvt_pk_bf16_f32 v107, v38, v39
    v_cvt_pk_bf16_f32 v108, v40, v41
    v_cvt_pk_bf16_f32 v109, v42, v43
    v_cvt_pk_bf16_f32 v110, v44, v45
    v_cvt_pk_bf16_f32 v111, v46, v47
    s_nop 1
    v_mfma_f32_32x32x16_bf16 v[64:79], v[128:131], v[96:99], v[64:79]
    v_mfma_f32_32x32x16_bf16 v[80:95], v[128:131], v[104:107], v[80:95]
    v_mfma_f32_32x32x16_bf16 v[64:79], v[132:135], v[100:103], v[64:79]
    v_mfma_f32_32x32x16_bf16 v[80:95], v[132:135], v[108:111], v[80:95]
    s_add_u32 s38, s38, 2560
    s_add_u32 s48, s48, 1
    s_cmp_lt_u32 s48, 64
    s_cbranch_scc1 L_fb2
    v_mov_b32 v148, 0
    v_mov_b32 v149, 0
    s_nop 7
    s_branch L_merge
L_fin:
L_end:
    s_endpgm
.section .rodata,"a"
.p2align 6
.amdhsa_kernel parallel_sum__mha_block__dense_activation_relu__prompt_kernel
  .amdhsa_next_free_vgpr 256
  .amdhsa_next_free_sgpr 102
  .amdhsa_accum_offset 256
  .amdhsa_group_segment_fixed_size 0
  .amdhsa_kernarg_size 72
  .amdhsa_user_sgpr_count 2
  .amdhsa_user_sgpr_kernarg_segment_ptr 1
  .amdhsa_system_sgpr_workgroup_id_x 1
  .amdhsa_float_denorm_mode_32 0
.end_amdhsa_kernel
```
